```python
import torch

def _softmax(x, axis=-1):
    return torch.softmax(x, dim=axis)
def _gelu(x):
    return torch.nn.functional.gelu(x, approximate="tanh")
def _silu(x):
    return torch.nn.functional.silu(x)
def _sigmoid(x):
    return torch.sigmoid(x)
def _layernorm(x, axis=-1, eps=1e-5):
    m = x.mean(dim=axis, keepdim=True)
    v = x.var(dim=axis, keepdim=True, unbiased=False)
    return (x - m) / torch.sqrt(v + eps)
def _scatter_add(tgt, idx, src, axis=0):
    return tgt.clone().index_add_(axis, idx, src)
def _segment_sum(src, seg, n):
    out = torch.zeros((n,) + src.shape[1:], dtype=src.dtype)
    return out.index_add_(0, seg, src)
def _pad(x, pw):
    flat = tuple(v for pair in reversed(pw) for v in pair)
    return torch.nn.functional.pad(x, flat)

kernel_name = 'recurrent_scan__ssm_conv_h3__swiglu_ffn__prompt'

def setup_inputs():

    _w = (lambda a: (lambda t: t.to(torch.bfloat16) if t.is_floating_point() else t)(torch.as_tensor(a)))
    def _A_setup():
        B, S, D = 1, 2048, 448
        ks = 4
        return {
            "q": _w((lambda *s: torch.randn(*s, dtype=torch.bfloat16) * 0.05)(B, S, D)),
            "k": _w((lambda *s: torch.randn(*s, dtype=torch.bfloat16) * 0.2)(B, S, D)),
            "v": _w((lambda *s: torch.randn(*s, dtype=torch.bfloat16) * 0.2)(B, S, D)),
            "shift_k": _w((lambda *s: torch.randn(*s, dtype=torch.bfloat16) * 0.2)(D, ks) * 0.5),
            "ssm_k": _w((lambda *s: torch.randn(*s, dtype=torch.bfloat16) * 0.2)(D, S) * (1.0 / S ** 0.5)),
            "ssm_D": _w((lambda *s: torch.randn(*s, dtype=torch.bfloat16) * 0.2)(D)),
        }
    _A_in = _A_setup()

    def _B_setup():
        B, S, D, F = 1, 2048, 448, 1792
        return {
            "x": _w((lambda *s: torch.randn(*s, dtype=torch.bfloat16) * 0.05)(B, S, D)),
            "w_gate": _w((lambda *s: torch.randn(*s, dtype=torch.bfloat16) * 0.1)(D, F)),
            "w_up": _w((lambda *s: torch.randn(*s, dtype=torch.bfloat16) * 0.1)(D, F)),
            "w_down": _w((lambda *s: torch.randn(*s, dtype=torch.bfloat16) * 0.1)(F, D)),
        }
    _B_in = _B_setup()

    return {
        "A_q": _A_in["q"],
        "A_k": _A_in["k"],
        "A_v": _A_in["v"],
        "A_shift_k": _A_in["shift_k"],
        "A_ssm_k": _A_in["ssm_k"],
        "A_ssm_D": _A_in["ssm_D"],
        "B_x": _B_in["x"],
        "B_w_gate": _B_in["w_gate"],
        "B_w_up": _B_in["w_up"],
        "B_w_down": _B_in["w_down"],
    }

def reference(A_q, A_k, A_v, A_shift_k, A_ssm_k, A_ssm_D, B_x, B_w_gate, B_w_up, B_w_down):
    def _A_ref(q, k, v, shift_k, ssm_k, ssm_D):
        B, S, D = q.shape
        ks = shift_k.shape[-1]
        k_pad = _pad(k, ((0, 0), (ks - 1, 0), (0, 0)))
        k_shift = torch.zeros_like(k)
        for t in range(ks):
            k_shift = k_shift + k_pad[:, t:t + S, :] * shift_k[:, ks - 1 - t][None, None, :]
        kv = k_shift * v
        L = 2 * S
        kv_pad = _pad(kv, ((0, 0), (0, S), (0, 0)))
        kf_pad = _pad(ssm_k, ((0, 0), (0, S)))
        kv_f = (lambda x, axes=(-2,-1): torch.fft.rfft2(x.float(), dim=axes))(kv_pad[:, None, :, :], axes=(1, 2))
        kf_f = (lambda x, axes=(-2,-1): torch.fft.rfft2(x.float(), dim=axes))(kf_pad[:, None, :], axes=(1, 2))
        kf_f = (lambda x, *d: x.permute(*d))(kf_f, 1, 2, 0)
        y_f = kv_f * kf_f[None, :, :, :]
        y = (lambda x, s, axes=(-2,-1): torch.fft.irfft2(x, s=s, dim=axes).to(torch.bfloat16))(y_f, (1, L), axes=(1, 2))[:, 0, :S, :]
        y = y + kv * ssm_D[None, None, :]
        return q * y

    def _B_ref(x, w_gate, w_up, w_down):
        g = _silu(x @ w_gate)
        u = x @ w_up
        return (g * u) @ w_down

    x = A_q
    xn = _layernorm(x, axis=-1)
    s = _A_ref(xn, A_k, A_v, A_shift_k, A_ssm_k, A_ssm_D)
    g = _silu(_B_ref(xn, B_w_gate, B_w_up, B_w_down))
    return x + s * g
```

```asm
; @launch grid=(256,1,1) block=(256,1,1) lds=163840
.amdgcn_target "amdgcn-amd-amdhsa--gfx950"
.text
.globl recurrent_scan__ssm_conv_h3__swiglu_ffn__prompt_kernel
.p2align 8
.type recurrent_scan__ssm_conv_h3__swiglu_ffn__prompt_kernel,@function
recurrent_scan__ssm_conv_h3__swiglu_ffn__prompt_kernel:
Lstart:
  s_cmp_ge_u32 s2, 256
  s_cbranch_scc1 Lend
  s_load_dwordx2 s[4:5], s[0:1], 0
  s_load_dwordx2 s[28:29], s[0:1], 56
  s_load_dwordx2 s[32:33], s[0:1], 64
  s_getpc_b64 s[64:65]
Lpc0:
  s_cmp_lt_u32 s2, 32
  s_cselect_b32 s57, Lend-Lpc0, 0
  v_lshlrev_b32 v14, 7, v0
  v_min_u32 v14, s57, v14
  global_load_dword a2, v14, s[64:65]
  v_lshrrev_b32 v14, 6, v0
  v_and_b32 v1, 63, v0
  v_readfirstlane_b32 s52, v14
  v_lshlrev_b32 v2, 4, v1
  s_mov_b32 s7, 0x20000
  s_mov_b32 s6, 1835008
  s_mov_b32 s30, 1605632
  s_mov_b32 s31, s7
  s_mov_b32 s34, 1605632
  s_mov_b32 s35, s7
  s_and_b32 s57, s2, 7
  s_lshr_b32 s58, s2, 3
  s_cmp_lt_u32 s2, 32
  s_cbranch_scc1 Lhelper
  s_sub_u32 s58, s58, 4
  s_mul_i32 s59, s58, 37
  s_lshr_b32 s59, s59, 8
  s_mul_i32 s60, s59, 7
  s_sub_u32 s56, s58, s60
  s_lshr_b32 s60, s57, 1
  s_lshl_b32 s60, s60, 2
  s_add_u32 s53, s60, s59
  s_and_b32 s57, s57, 1
  s_mul_i32 s60, s57, 7
  s_add_u32 s54, s60, s56
  s_lshl_b32 s60, s53, 1
  s_add_u32 s55, s60, s57
  s_lshl_b32 s57, s53, 7
  s_lshl_b32 s58, s52, 5
  s_add_u32 s57, s57, s58
  s_mul_i32 s58, s59, 2
  s_add_u32 s58, s58, 2
  s_lshr_b32 s58, s58, 2
  s_lshl_b32 s65, s58, 7
  s_mul_i32 s62, s58, 229376
  s_movk_i32 s59, 896
  v_lshrrev_b32 v14, 3, v1
  v_add_u32 v14, s57, v14
  v_lshrrev_b32 v15, 4, v1
  v_xor_b32 v4, v15, v1
  v_and_b32 v4, 7, v4
  v_lshlrev_b32 v4, 4, v4
  v_mad_u32_u24 v4, v14, s59, v4
  v_xor_b32 v5, 64, v4
  v_add_u32 v5, 6144, v5
  s_lshl_b32 s63, s52, 12
  s_add_u32 s66, s65, 12288
  v_and_b32 v14, 31, v1
  v_add_u32 v14, s57, v14
  v_mul_u32_u24 v13, s59, v14
  s_lshl_b32 s57, s52, 3
  s_movk_i32 s59, 3584
  v_lshlrev_b32 v6, 6, v15
  v_xor_b32 v6, v6, v2
  v_and_b32 v6, 0xff, v6
  v_add_u32 v14, s57, v15
  v_mad_u32_u24 v6, v14, s59, v6
  s_lshl_b32 s57, s54, 8
  v_add_u32 v6, s57, v6
  v_add_u32 v7, 13312, v6
  s_lshl_b32 s60, s52, 11
  s_lshl_b32 s61, s56, 7
  s_add_u32 s34, s34, 2048
  s_waitcnt lgkmcnt(0)
  s_sub_u32 s32, s32, 2048
  s_subb_u32 s33, s33, 0
  s_add_u32 m0, s63, 1024
  s_nop 0
  buffer_load_dwordx4 v4, s[4:7], s65 offen lds
  buffer_load_dwordx4 v5, s[4:7], s65 offen offset:1024 lds
  buffer_load_dwordx4 v4, s[4:7], s66 offen offset:2048 lds
  buffer_load_dwordx4 v5, s[4:7], s66 offen offset:3072 lds
  s_add_u32 s65, s65, 128
  s_cmp_eq_u32 s65, 896
  s_cselect_b32 s65, 0, s65
  s_add_u32 s66, s65, 12288
  s_add_u32 m0, s63, 17408
  s_nop 0
  buffer_load_dwordx4 v6, s[28:31], s62 offen lds
  buffer_load_dwordx4 v6, s[32:35], s62 offen offset:2048 lds
  buffer_load_dwordx4 v7, s[28:31], s62 offen offset:1024 lds
  buffer_load_dwordx4 v7, s[32:35], s62 offen offset:3072 lds
  s_add_u32 s62, s62, 114688
  s_load_dwordx2 s[48:49], s[0:1], 96
  s_load_dwordx2 s[44:45], s[0:1], 88
  s_load_dwordx2 s[8:9], s[0:1], 8
  s_load_dwordx2 s[12:13], s[0:1], 16
  s_load_dwordx2 s[16:17], s[0:1], 24
  s_load_dwordx2 s[20:21], s[0:1], 32
  s_load_dwordx2 s[24:25], s[0:1], 40
  s_load_dwordx2 s[36:37], s[0:1], 72
  s_load_dwordx2 s[40:41], s[0:1], 80
  s_mov_b32 s10, 1835008
  s_mov_b32 s11, s7
  s_mov_b32 s14, 1835008
  s_mov_b32 s15, s7
  s_mov_b32 s18, 3584
  s_mov_b32 s19, s7
  s_mov_b32 s26, 896
  s_mov_b32 s27, s7
  v_lshrrev_b32 v84, 3, v1
  s_movk_i32 s59, 896
  s_lshl_b32 s3, s56, 9
  s_lshl_b32 s57, s55, 6
  s_lshl_b32 s58, s52, 4
  s_add_u32 s58, s57, s58
  v_lshl_add_u32 v83, v84, 1, s58
  v_and_b32 v74, 0x70, v2
  v_add_u32 v85, s61, v74
  v_mad_u32_u24 v3, v83, s59, v85
  v_subrev_u32 v72, 2688, v3
  v_subrev_u32 v73, 1792, v3
  s_mov_b32 s22, 1835008
  s_mov_b32 s23, s7
  s_mov_b32 s38, 1605632
  s_mov_b32 s39, s7
  s_mov_b32 s42, 1835008
  s_mov_b32 s43, s7
  s_mov_b32 s46, 256
  s_mov_b32 s47, s7
  s_mov_b32 s50, 13631488
  s_mov_b32 s51, s7
  v_and_b32 v14, 31, v1
  v_lshrrev_b32 v15, 5, v1
  v_lshrrev_b32 v8, 1, v14
  v_xor_b32 v8, v8, v15
  v_and_b32 v8, 7, v8
  v_lshlrev_b32 v8, 4, v8
  v_lshl_add_u32 v8, v14, 7, v8
  v_xor_b32 v9, 32, v8
  v_xor_b32 v10, 64, v8
  v_xor_b32 v11, 0x60, v8
  v_bfe_u32 v80, v1, 2, 2
  v_bfe_u32 v81, v1, 4, 1
  v_and_b32 v82, 3, v1
  v_lshlrev_b32 v82, 3, v82
  v_lshl_add_u32 v82, v81, 5, v82
  v_lshl_add_u32 v12, v15, 4, v80
  v_lshl_add_u32 v12, v12, 8, v82
  v_xor_b32 v83, s52, v80
  v_lshl_add_u32 v12, v83, 6, v12
  v_add_u32 v13, 49152, v12
  s_mov_b32 s64, 0xffff0000
  s_mov_b32 s67, 0
  v_lshl_add_u32 v17, v15, 2, v80
  v_lshl_add_u32 v17, v17, 7, v82
  v_lshrrev_b32 v83, 1, v80
  v_lshl_add_u32 v17, v83, 6, v17
  v_add_u32 v17, s63, v17
  v_xor_b32 v18, 64, v17
  v_add_u32 v19, 49152, v17
  v_add_u32 v20, 49152, v18
  s_mul_i32 s57, s52, 448
  v_lshrrev_b32 v84, 3, v1
  v_add_u32 v83, s57, v84
  v_lshlrev_b32 v16, 6, v81
  v_xor_b32 v16, v16, v2
  v_and_b32 v16, 0x70, v16
  s_movk_i32 s59, 896
  v_add_u32 v16, s61, v16
  v_mad_u32_u24 v16, v83, s59, v16
  s_lshl_b32 s57, s55, 6
  s_and_b32 s3, s52, 1
  s_lshr_b32 s0, s52, 1
  v_bfe_u32 v86, v1, 3, 1
  v_lshl_add_u32 v86, v81, 3, v86
  v_lshl_add_u32 v86, v15, 1, v86
  s_lshl_b32 s58, s3, 2
  v_add_u32 v86, s58, v86
  s_lshl_b32 s58, s0, 4
  v_add_u32 v87, s58, v86
  v_add_u32 v83, s57, v87
  v_mad_u32_u24 v88, v83, s59, v85
  v_accvgpr_write_b32 a224, v88
  v_lshlrev_b32 v88, 3, v83
  v_accvgpr_write_b32 a225, v88
  v_and_b32 v89, 7, v1
  v_mul_u32_u24 v90, 1040, v89
  v_lshlrev_b32 v88, 1, v87
  v_sub_u32 v88, v90, v88
  v_add_u32 v88, 153406, v88
  v_accvgpr_write_b32 a226, v88
  v_lshlrev_b32 v88, 1, v89
  v_and_b32 v91, 7, v86
  v_xor_b32 v88, v88, v91
  v_lshlrev_b32 v88, 4, v88
  v_lshl_add_u32 v88, v86, 8, v88
  s_lshl_b32 s58, s0, 14
  v_add_u32 v88, s58, v88
  v_accvgpr_write_b32 a227, v88
  v_xor_b32 v88, v89, v15
  v_lshlrev_b32 v88, 4, v88
  v_and_b32 v91, 15, v1
  v_lshl_add_u32 v88, v91, 8, v88
  v_lshl_add_u32 v88, v81, 14, v88
  v_add_u32 v88, s63, v88
  v_accvgpr_write_b32 a228, v88
  v_bfe_u32 v88, v1, 2, 3
  v_lshl_add_u32 v88, v88, 2, v15
  v_and_b32 v91, 48, v2
  v_lshl_add_u32 v88, v88, 8, v91
  v_accvgpr_write_b32 a229, v88
  v_lshlrev_b32 v88, 2, v84
  v_lshl_add_u32 v88, v89, 6, v88
  s_add_u32 s58, s60, 132096
  v_add_u32 v88, s58, v88
  v_accvgpr_write_b32 a230, v88
  v_mul_u32_u24 v88, 57344, v80
  v_lshl_add_u32 v88, v81, 7, v88
  v_lshl_add_u32 v88, v15, 5, v88
  v_bfe_u32 v91, v1, 1, 1
  v_lshl_add_u32 v88, v91, 6, v88
  v_and_b32 v91, 1, v1
  v_lshl_add_u32 v88, v91, 4, v88
  v_accvgpr_write_b32 a231, v88
  v_lshlrev_b32 v88, 2, v84
  v_sub_u32 v88, v90, v88
  s_lshl_b32 s57, s52, 5
  s_sub_u32 s58, 153468, s57
  v_add_u32 v88, s58, v88
  v_accvgpr_write_b32 a232, v88
  s_mul_i32 s58, s52, 2080
  s_add_u32 s58, s58, 153344
  v_add_u32 v88, s58, v2
  v_accvgpr_write_b32 a233, v88
  v_lshl_add_u32 v88, v84, 12, v74
  v_accvgpr_write_b32 a234, v88
  s_lshl_b32 s58, s53, 7
  v_add_lshl_u32 v88, v14, s58, 3
  v_accvgpr_write_b32 a235, v88
  s_lshl_b32 s58, s54, 7
  s_add_u32 s58, s58, s57
  v_add_lshl_u32 v88, v14, s58, 3
  v_accvgpr_write_b32 a236, v88
  s_lshl_b32 s57, s3, 1
  s_lshl_b32 s58, s3, 11
  v_add_u32 v23, s58, v2
  s_mul_i32 s1, s0, 27008
  s_mul_i32 s58, s3, 4224
  s_add_u32 s71, s1, s58
  s_add_u32 s58, s57, s71
  s_add_u32 s58, s58, 121982
  v_lshl_add_u32 v88, v1, 1, s58
  v_accvgpr_write_b32 a237, v88
  s_add_u32 s71, s1, 117872
  s_lshl_b32 s58, s3, 8
  s_add_u32 s58, s58, s1
  s_add_u32 s58, s58, 99328
  v_and_b32 v88, 48, v1
  v_add_u32 v88, s58, v88
  v_mul_u32_u24 v92, 4224, v91
  v_bfe_u32 v21, v1, 1, 3
  v_lshlrev_b32 v21, 4, v21
  v_sub_u32 v21, v92, v21
  v_add_u32 v92, 18672, v88
  v_add_u32 v21, v21, v92
  v_and_b32 v92, 3, v1
  v_mul_u32_u24 v92, 4640, v92
  v_lshlrev_b32 v22, 7, v80
  v_add3_u32 v22, v22, v92, v88
  s_mul_i32 s58, s3, 9280
  s_add_u32 s70, s1, s58
  v_mul_u32_u24 v88, 4128, v15
  v_add3_u32 v88, v88, v2, s70
  v_add_u32 v88, 99328, v88
  v_mov_b32 v92, 0
  v_mov_b32 v93, 0
  v_mov_b32 v94, 0
  v_mov_b32 v95, 0
  s_lshl_b32 s58, s3, 3
  s_sub_u32 s70, s70, s58
  ds_write_b128 v88, v[92:95]
  s_lshl_b32 s57, s56, 18
  s_lshl_b32 s58, s52, 16
  s_add_u32 s57, s57, s58
  s_lshl_b32 s58, s55, 7
  s_sub_u32 s57, s57, s58
  s_add_u32 s68, s57, 135040
  s_lshl_b32 s57, s56, 5
  s_add_u32 s57, s57, s55
  s_lshl_b32 s58, s57, 1
  s_add_u32 s58, s58, s0
  s_lshl_b32 s69, s58, 12
  s_lshl_b32 s57, s57, 8
  s_mul_i32 s58, s52, 458752
  s_add_u32 s57, s57, s58
  s_add_u32 s76, s57, 2097152
  s_and_b32 s57, s2, 7
  s_lshl_b32 s58, s56, 3
  s_add_u32 s58, s58, s57
  s_lshl_b32 s72, s58, 7
  s_add_u32 s74, s72, 7168
  s_lshl_b32 s57, s55, 7
  s_add_u32 s73, s57, 14336
  s_mul_i32 s57, s53, 448
  s_lshl_b32 s58, s54, 3
  s_add_u32 s57, s57, s58
  s_lshl_b32 s58, s52, 1
  s_add_u32 s57, s57, s58
  s_lshl_b32 s57, s57, 10
  s_add_u32 s75, s57, 4194304
  s_mul_i32 s57, s55, 224
  s_mul_i32 s58, s52, 28
  s_add_u32 s57, s57, s58
  s_lshl_b32 s57, s57, 10
  s_add_u32 s77, s57, 4194304
  s_mul_i32 s57, s55, 57344
  s_lshl_b32 s58, s56, 13
  s_add_u32 s57, s57, s58
  s_lshl_b32 s58, s52, 6
  s_add_u32 s57, s57, s58
  s_add_u32 s78, s57, 2097152
  s_mov_b32 s79, 32768
  s_add_u32 s0, s60, 99328
  s_lshl_b32 s3, s56, 9
  s_add_u32 m0, s63, 33792
  s_nop 0
  buffer_load_dwordx4 v6, s[28:31], s62 offen lds
  buffer_load_dwordx4 v6, s[32:35], s62 offen offset:2048 lds
  buffer_load_dwordx4 v7, s[28:31], s62 offen offset:1024 lds
  buffer_load_dwordx4 v7, s[32:35], s62 offen offset:3072 lds
  s_mul_i32 s62, s65, 1792
  s_waitcnt lgkmcnt(0)
  s_waitcnt vmcnt(4)
  s_barrier
  ds_read_b64_tr_b16 v[96:97], v12 offset:17408
  ds_read_b64_tr_b16 v[98:99], v12 offset:18432
  ds_read_b128 v[80:83], v8 offset:1024
  ds_read_b64_tr_b16 v[100:101], v12 offset:19456
  ds_read_b64_tr_b16 v[102:103], v12 offset:20480
  ds_read_b128 v[84:87], v8 offset:5120
  ds_read_b128 v[88:91], v8 offset:9216
  ds_read_b128 v[92:95], v8 offset:13312
  v_xor_b32 v8, 49152, v8
  s_waitcnt lgkmcnt(5)
  v_mfma_f32_32x32x16_bf16 v[128:143], v[96:99], v[80:83], 0
  s_add_u32 m0, s63, 50176
  ds_read_b64_tr_b16 v[120:121], v12 offset:25600
  buffer_load_dwordx4 v4, s[4:7], s65 offen lds
  buffer_load_dwordx4 v5, s[4:7], s65 offen offset:1024 lds
  s_waitcnt lgkmcnt(3)
  v_mfma_f32_32x32x16_bf16 v[144:159], v[100:103], v[80:83], 0
  ds_read_b64_tr_b16 v[122:123], v12 offset:26624
  buffer_load_dwordx4 v4, s[4:7], s66 offen offset:2048 lds
  buffer_load_dwordx4 v5, s[4:7], s66 offen offset:3072 lds
  v_mfma_f32_32x32x16_bf16 v[160:175], v[96:99], v[84:87], 0
  ds_read_b128 v[104:107], v9 offset:1024
  s_add_u32 s65, s65, 128
  s_cmp_eq_u32 s65, 896
  s_cselect_b32 s65, 0, s65
  s_add_u32 s66, s65, 12288
  s_add_u32 m0, s63, 66560
  v_mfma_f32_32x32x16_bf16 v[176:191], v[100:103], v[84:87], 0
  ds_read_b64_tr_b16 v[124:125], v12 offset:27648
  buffer_load_dwordx4 v6, s[28:31], s62 offen lds
  buffer_load_dwordx4 v6, s[32:35], s62 offen offset:2048 lds
  s_waitcnt lgkmcnt(4)
  v_mfma_f32_32x32x16_bf16 v[192:207], v[96:99], v[88:91], 0
  ds_read_b64_tr_b16 v[126:127], v12 offset:28672
  buffer_load_dwordx4 v7, s[28:31], s62 offen offset:1024 lds
  buffer_load_dwordx4 v7, s[32:35], s62 offen offset:3072 lds
  s_add_u32 s62, s62, 114688
  s_add_u32 m0, s63, 82944
  v_mfma_f32_32x32x16_bf16 v[208:223], v[100:103], v[88:91], 0
  ds_read_b128 v[108:111], v9 offset:5120
  buffer_load_dwordx4 v6, s[28:31], s62 offen lds
  buffer_load_dwordx4 v6, s[32:35], s62 offen offset:2048 lds
  v_mfma_f32_32x32x16_bf16 v[224:239], v[96:99], v[92:95], 0
  ds_read_b128 v[112:115], v9 offset:9216
  buffer_load_dwordx4 v7, s[28:31], s62 offen offset:1024 lds
  v_mfma_f32_32x32x16_bf16 v[240:255], v[100:103], v[92:95], 0
  ds_read_b128 v[116:119], v9 offset:13312
  v_xor_b32 v9, 49152, v9
  buffer_load_dwordx4 v7, s[32:35], s62 offen offset:3072 lds
  s_mul_i32 s62, s65, 1792
  s_waitcnt lgkmcnt(5)
  v_mfma_f32_32x32x16_bf16 v[128:143], v[120:123], v[104:107], v[128:143]
  s_waitcnt lgkmcnt(2)
  v_mfma_f32_32x32x16_bf16 v[144:159], v[124:127], v[104:107], v[144:159]
  s_waitcnt vmcnt(12) lgkmcnt(0)
  s_barrier
  ds_read_b64_tr_b16 v[96:97], v12 offset:33792
  ds_read_b64_tr_b16 v[98:99], v12 offset:34816
  v_mfma_f32_32x32x16_bf16 v[160:175], v[120:123], v[108:111], v[160:175]
  s_add_u32 m0, s63, 17408
  ds_read_b128 v[80:83], v10 offset:1024
  buffer_load_dwordx4 v6, s[28:31], s62 offen lds
  buffer_load_dwordx4 v6, s[32:35], s62 offen offset:2048 lds
  v_mfma_f32_32x32x16_bf16 v[176:191], v[124:127], v[108:111], v[176:191]
  ds_read_b64_tr_b16 v[100:101], v12 offset:35840
  buffer_load_dwordx4 v7, s[28:31], s62 offen offset:1024 lds
  buffer_load_dwordx4 v7, s[32:35], s62 offen offset:3072 lds
  s_add_u32 s62, s62, 114688
  v_mfma_f32_32x32x16_bf16 v[192:207], v[120:123], v[112:115], v[192:207]
  ds_read_b64_tr_b16 v[102:103], v12 offset:36864
  v_mfma_f32_32x32x16_bf16 v[208:223], v[124:127], v[112:115], v[208:223]
  ds_read_b128 v[84:87], v10 offset:5120
  v_mfma_f32_32x32x16_bf16 v[224:239], v[120:123], v[116:119], v[224:239]
  ds_read_b128 v[88:91], v10 offset:9216
  v_mfma_f32_32x32x16_bf16 v[240:255], v[124:127], v[116:119], v[240:255]
  ds_read_b128 v[92:95], v10 offset:13312
  v_xor_b32 v10, 49152, v10
  s_waitcnt lgkmcnt(5)
  v_mfma_f32_32x32x16_bf16 v[128:143], v[96:99], v[80:83], v[128:143]
  ds_read_b64_tr_b16 v[120:121], v12 offset:41984
  s_waitcnt lgkmcnt(3)
  v_mfma_f32_32x32x16_bf16 v[144:159], v[100:103], v[80:83], v[144:159]
  ds_read_b64_tr_b16 v[122:123], v12 offset:43008
  v_mfma_f32_32x32x16_bf16 v[160:175], v[96:99], v[84:87], v[160:175]
  ds_read_b128 v[104:107], v11 offset:1024
  v_mfma_f32_32x32x16_bf16 v[176:191], v[100:103], v[84:87], v[176:191]
  ds_read_b64_tr_b16 v[124:125], v12 offset:44032
  s_waitcnt lgkmcnt(4)
  v_mfma_f32_32x32x16_bf16 v[192:207], v[96:99], v[88:91], v[192:207]
  ds_read_b64_tr_b16 v[126:127], v12 offset:45056
  v_mfma_f32_32x32x16_bf16 v[208:223], v[100:103], v[88:91], v[208:223]
  ds_read_b128 v[108:111], v11 offset:5120
  v_mfma_f32_32x32x16_bf16 v[224:239], v[96:99], v[92:95], v[224:239]
  ds_read_b128 v[112:115], v11 offset:9216
  v_mfma_f32_32x32x16_bf16 v[240:255], v[100:103], v[92:95], v[240:255]
  ds_read_b128 v[116:119], v11 offset:13312
  v_xor_b32 v11, 49152, v11
  s_waitcnt lgkmcnt(5)
  v_mfma_f32_32x32x16_bf16 v[128:143], v[120:123], v[104:107], v[128:143]
  s_waitcnt lgkmcnt(2)
  v_mfma_f32_32x32x16_bf16 v[144:159], v[124:127], v[104:107], v[144:159]
  s_waitcnt vmcnt(8) lgkmcnt(0)
  s_barrier
  ds_read_b64_tr_b16 v[96:97], v13 offset:17408
  ds_read_b64_tr_b16 v[98:99], v13 offset:18432
  v_mfma_f32_32x32x16_bf16 v[160:175], v[120:123], v[108:111], v[160:175]
  s_add_u32 m0, s63, 1024
  ds_read_b128 v[80:83], v8 offset:1024
  buffer_load_dwordx4 v4, s[4:7], s65 offen lds
  buffer_load_dwordx4 v5, s[4:7], s65 offen offset:1024 lds
  v_mfma_f32_32x32x16_bf16 v[176:191], v[124:127], v[108:111], v[176:191]
  ds_read_b64_tr_b16 v[100:101], v13 offset:19456
  buffer_load_dwordx4 v4, s[4:7], s66 offen offset:2048 lds
  buffer_load_dwordx4 v5, s[4:7], s66 offen offset:3072 lds
  s_add_u32 s65, s65, 128
  s_cmp_eq_u32 s65, 896
  s_cselect_b32 s65, 0, s65
  v_mfma_f32_32x32x16_bf16 v[192:207], v[120:123], v[112:115], v[192:207]
  ds_read_b64_tr_b16 v[102:103], v13 offset:20480
  s_add_u32 s66, s65, 12288
  s_add_u32 m0, s63, 33792
  s_nop 0
  buffer_load_dwordx4 v6, s[28:31], s62 offen lds
  buffer_load_dwordx4 v6, s[32:35], s62 offen offset:2048 lds
  v_mfma_f32_32x32x16_bf16 v[208:223], v[124:127], v[112:115], v[208:223]
  ds_read_b128 v[84:87], v8 offset:5120
  buffer_load_dwordx4 v7, s[28:31], s62 offen offset:1024 lds
  v_mfma_f32_32x32x16_bf16 v[224:239], v[120:123], v[116:119], v[224:239]
  ds_read_b128 v[88:91], v8 offset:9216
  buffer_load_dwordx4 v7, s[32:35], s62 offen offset:3072 lds
  s_mul_i32 s62, s65, 1792
  s_mov_b32 m0, 0
  s_nop 0
  buffer_load_dwordx4 v2, s[16:19], s3 offen lds
  v_mfma_f32_32x32x16_bf16 v[240:255], v[124:127], v[116:119], v[240:255]
  ds_read_b128 v[92:95], v8 offset:13312
  v_xor_b32 v8, 49152, v8
  buffer_load_dwordx4 v[40:43], v3, s[8:11], 0 offen nt
  buffer_load_dwordx4 v[44:47], v3, s[8:11], 0 offen offset:896 nt
  s_waitcnt lgkmcnt(5)
  v_mfma_f32_32x32x16_bf16 v[128:143], v[96:99], v[80:83], v[128:143]
  ds_read_b64_tr_b16 v[120:121], v13 offset:25600
  buffer_load_dwordx4 v[48:51], v3, s[12:15], 0 offen nt
  buffer_load_dwordx4 v[52:55], v3, s[12:15], 0 offen offset:896 nt
  s_waitcnt lgkmcnt(3)
  v_mfma_f32_32x32x16_bf16 v[144:159], v[100:103], v[80:83], v[144:159]
  ds_read_b64_tr_b16 v[122:123], v13 offset:26624
  buffer_load_dwordx4 v[28:31], v72, s[8:11], 0 offen nt
  buffer_load_dwordx4 v[32:35], v73, s[8:11], 0 offen nt
  v_mfma_f32_32x32x16_bf16 v[160:175], v[96:99], v[84:87], v[160:175]
  ds_read_b128 v[104:107], v9 offset:1024
  buffer_load_dwordx4 v[36:39], v73, s[8:11], 0 offen offset:896 nt
  buffer_load_dwordx4 v[24:27], v74, s[24:27], s61 offen
  v_mfma_f32_32x32x16_bf16 v[176:191], v[100:103], v[84:87], v[176:191]
  ds_read_b64_tr_b16 v[124:125], v13 offset:27648
  s_waitcnt lgkmcnt(4)
  v_mfma_f32_32x32x16_bf16 v[192:207], v[96:99], v[88:91], v[192:207]
  ds_read_b64_tr_b16 v[126:127], v13 offset:28672
  v_mfma_f32_32x32x16_bf16 v[208:223], v[100:103], v[88:91], v[208:223]
  ds_read_b128 v[108:111], v9 offset:5120
  v_mfma_f32_32x32x16_bf16 v[224:239], v[96:99], v[92:95], v[224:239]
  ds_read_b128 v[112:115], v9 offset:9216
  v_mfma_f32_32x32x16_bf16 v[240:255], v[100:103], v[92:95], v[240:255]
  ds_read_b128 v[116:119], v9 offset:13312
  v_xor_b32 v9, 49152, v9
  s_waitcnt lgkmcnt(5)
  v_mfma_f32_32x32x16_bf16 v[128:143], v[120:123], v[104:107], v[128:143]
  s_waitcnt lgkmcnt(2)
  v_mfma_f32_32x32x16_bf16 v[144:159], v[124:127], v[104:107], v[144:159]
  s_waitcnt vmcnt(21) lgkmcnt(0)
  s_barrier
  ds_read_b64_tr_b16 v[96:97], v13 offset:33792
  ds_read_b64_tr_b16 v[98:99], v13 offset:34816
  v_mfma_f32_32x32x16_bf16 v[160:175], v[120:123], v[108:111], v[160:175]
  s_add_u32 m0, s63, 66560
  ds_read_b128 v[80:83], v10 offset:1024
  buffer_load_dwordx4 v6, s[28:31], s62 offen lds
  v_mfma_f32_32x32x16_bf16 v[176:191], v[124:127], v[108:111], v[176:191]
  ds_read_b64_tr_b16 v[100:101], v13 offset:35840
  buffer_load_dwordx4 v6, s[32:35], s62 offen offset:2048 lds
  v_mfma_f32_32x32x16_bf16 v[192:207], v[120:123], v[112:115], v[192:207]
  ds_read_b64_tr_b16 v[102:103], v13 offset:36864
  buffer_load_dwordx4 v7, s[28:31], s62 offen offset:1024 lds
  v_mfma_f32_32x32x16_bf16 v[208:223], v[124:127], v[112:115], v[208:223]
  ds_read_b128 v[84:87], v10 offset:5120
  buffer_load_dwordx4 v7, s[32:35], s62 offen offset:3072 lds
  s_add_u32 s62, s62, 114688
  v_mfma_f32_32x32x16_bf16 v[224:239], v[120:123], v[116:119], v[224:239]
  ds_read_b128 v[88:91], v10 offset:9216
  v_mfma_f32_32x32x16_bf16 v[240:255], v[124:127], v[116:119], v[240:255]
  ds_read_b128 v[92:95], v10 offset:13312
  v_xor_b32 v10, 49152, v10
  s_waitcnt lgkmcnt(5)
  v_mfma_f32_32x32x16_bf16 v[128:143], v[96:99], v[80:83], v[128:143]
  ds_read_b64_tr_b16 v[120:121], v13 offset:41984
  s_waitcnt lgkmcnt(3)
  v_mfma_f32_32x32x16_bf16 v[144:159], v[100:103], v[80:83], v[144:159]
  ds_read_b64_tr_b16 v[122:123], v13 offset:43008
  v_mfma_f32_32x32x16_bf16 v[160:175], v[96:99], v[84:87], v[160:175]
  ds_read_b128 v[104:107], v11 offset:1024
  v_mfma_f32_32x32x16_bf16 v[176:191], v[100:103], v[84:87], v[176:191]
  ds_read_b64_tr_b16 v[124:125], v13 offset:44032
  s_waitcnt lgkmcnt(4)
  v_mfma_f32_32x32x16_bf16 v[192:207], v[96:99], v[88:91], v[192:207]
  ds_read_b64_tr_b16 v[126:127], v13 offset:45056
  v_mfma_f32_32x32x16_bf16 v[208:223], v[100:103], v[88:91], v[208:223]
  ds_read_b128 v[108:111], v11 offset:5120
  v_mfma_f32_32x32x16_bf16 v[224:239], v[96:99], v[92:95], v[224:239]
  ds_read_b128 v[112:115], v11 offset:9216
  v_mfma_f32_32x32x16_bf16 v[240:255], v[100:103], v[92:95], v[240:255]
  ds_read_b128 v[116:119], v11 offset:13312
  v_xor_b32 v11, 49152, v11
  s_waitcnt lgkmcnt(5)
  v_mfma_f32_32x32x16_bf16 v[128:143], v[120:123], v[104:107], v[128:143]
  s_waitcnt lgkmcnt(2)
  v_mfma_f32_32x32x16_bf16 v[144:159], v[124:127], v[104:107], v[144:159]
  s_waitcnt vmcnt(17) lgkmcnt(0)
  s_barrier
  ds_read_b64_tr_b16 v[96:97], v12 offset:17408
  ds_read_b64_tr_b16 v[98:99], v12 offset:18432
  v_mfma_f32_32x32x16_bf16 v[160:175], v[120:123], v[108:111], v[160:175]
  s_add_u32 m0, s63, 50176
  ds_read_b128 v[80:83], v8 offset:1024
  buffer_load_dwordx4 v4, s[4:7], s65 offen lds
  v_mfma_f32_32x32x16_bf16 v[176:191], v[124:127], v[108:111], v[176:191]
  ds_read_b64_tr_b16 v[100:101], v12 offset:19456
  buffer_load_dwordx4 v5, s[4:7], s65 offen offset:1024 lds
  v_mfma_f32_32x32x16_bf16 v[192:207], v[120:123], v[112:115], v[192:207]
  ds_read_b64_tr_b16 v[102:103], v12 offset:20480
  buffer_load_dwordx4 v4, s[4:7], s66 offen offset:2048 lds
  v_mfma_f32_32x32x16_bf16 v[208:223], v[124:127], v[112:115], v[208:223]
  ds_read_b128 v[84:87], v8 offset:5120
  buffer_load_dwordx4 v5, s[4:7], s66 offen offset:3072 lds
  s_add_u32 s65, s65, 128
  s_cmp_eq_u32 s65, 896
  s_cselect_b32 s65, 0, s65
  s_add_u32 s66, s65, 12288
  v_mfma_f32_32x32x16_bf16 v[224:239], v[120:123], v[116:119], v[224:239]
  ds_read_b128 v[88:91], v8 offset:9216
  s_add_u32 m0, s63, 82944
  v_mfma_f32_32x32x16_bf16 v[240:255], v[124:127], v[116:119], v[240:255]
  ds_read_b128 v[92:95], v8 offset:13312
  v_xor_b32 v8, 49152, v8
  buffer_load_dwordx4 v6, s[28:31], s62 offen lds
  s_waitcnt lgkmcnt(5)
  v_mfma_f32_32x32x16_bf16 v[128:143], v[96:99], v[80:83], v[128:143]
  ds_read_b64_tr_b16 v[120:121], v12 offset:25600
  buffer_load_dwordx4 v6, s[32:35], s62 offen offset:2048 lds
  s_waitcnt lgkmcnt(3)
  v_mfma_f32_32x32x16_bf16 v[144:159], v[100:103], v[80:83], v[144:159]
  ds_read_b64_tr_b16 v[122:123], v12 offset:26624
  buffer_load_dwordx4 v7, s[28:31], s62 offen offset:1024 lds
  v_mfma_f32_32x32x16_bf16 v[160:175], v[96:99], v[84:87], v[160:175]
  ds_read_b128 v[104:107], v9 offset:1024
  v_mfma_f32_32x32x16_bf16 v[176:191], v[100:103], v[84:87], v[176:191]
  ds_read_b64_tr_b16 v[124:125], v12 offset:27648
  buffer_load_dwordx4 v7, s[32:35], s62 offen offset:3072 lds
  s_mul_i32 s62, s65, 1792
  s_waitcnt lgkmcnt(4)
  v_mfma_f32_32x32x16_bf16 v[192:207], v[96:99], v[88:91], v[192:207]
  ds_read_b64_tr_b16 v[126:127], v12 offset:28672
  v_mfma_f32_32x32x16_bf16 v[208:223], v[100:103], v[88:91], v[208:223]
  ds_read_b128 v[108:111], v9 offset:5120
  v_mfma_f32_32x32x16_bf16 v[224:239], v[96:99], v[92:95], v[224:239]
  ds_read_b128 v[112:115], v9 offset:9216
  v_mfma_f32_32x32x16_bf16 v[240:255], v[100:103], v[92:95], v[240:255]
  ds_read_b128 v[116:119], v9 offset:13312
  v_xor_b32 v9, 49152, v9
  s_waitcnt lgkmcnt(5)
  v_mfma_f32_32x32x16_bf16 v[128:143], v[120:123], v[104:107], v[128:143]
  s_waitcnt lgkmcnt(2)
  v_mfma_f32_32x32x16_bf16 v[144:159], v[124:127], v[104:107], v[144:159]
  s_waitcnt vmcnt(21) lgkmcnt(0)
  s_barrier
  ds_read_b64_tr_b16 v[96:97], v12 offset:33792
  ds_read_b64_tr_b16 v[98:99], v12 offset:34816
  v_mfma_f32_32x32x16_bf16 v[160:175], v[120:123], v[108:111], v[160:175]
  s_add_u32 m0, s63, 17408
  ds_read_b128 v[80:83], v10 offset:1024
  buffer_load_dwordx4 v6, s[28:31], s62 offen lds
  v_mfma_f32_32x32x16_bf16 v[176:191], v[124:127], v[108:111], v[176:191]
  ds_read_b64_tr_b16 v[100:101], v12 offset:35840
  buffer_load_dwordx4 v6, s[32:35], s62 offen offset:2048 lds
  v_mfma_f32_32x32x16_bf16 v[192:207], v[120:123], v[112:115], v[192:207]
  ds_read_b64_tr_b16 v[102:103], v12 offset:36864
  buffer_load_dwordx4 v7, s[28:31], s62 offen offset:1024 lds
  s_waitcnt vmcnt(15)
  v_lshlrev_b32 v14, 2, v74
  v_accvgpr_read_b32 v3, a232
  ds_read_b128 v[56:59], v14 offset:0
  v_mfma_f32_32x32x16_bf16 v[208:223], v[124:127], v[112:115], v[208:223]
  ds_read_b128 v[84:87], v10 offset:5120
  buffer_load_dwordx4 v7, s[32:35], s62 offen offset:3072 lds
  s_add_u32 s62, s62, 114688
  ds_read_b128 v[60:63], v14 offset:16
  ds_read_b128 v[64:67], v14 offset:32
  ds_read_b128 v[68:71], v14 offset:48
  v_mfma_f32_32x32x16_bf16 v[224:239], v[120:123], v[116:119], v[224:239]
  ds_read_b128 v[88:91], v10 offset:9216
  v_lshlrev_b32 v72, 16, v28
  v_lshlrev_b32 v73, 16, v32
  v_lshlrev_b32 v74, 16, v36
  v_lshlrev_b32 v75, 16, v40
  v_mfma_f32_32x32x16_bf16 v[240:255], v[124:127], v[116:119], v[240:255]
  ds_read_b128 v[92:95], v10 offset:13312
  v_xor_b32 v10, 49152, v10
  v_lshlrev_b32 v76, 16, v44
  s_waitcnt lgkmcnt(2)
  v_lshlrev_b32 v77, 16, v56
  v_mul_f32 v79, v76, v77
  v_mfma_f32_32x32x16_bf16 v[128:143], v[96:99], v[80:83], v[128:143]
  ds_read_b64_tr_b16 v[120:121], v12 offset:41984
  v_mul_f32 v78, v75, v77
  v_and_b32 v77, s64, v56
  v_fmac_f32 v79, v75, v77
  v_fmac_f32 v78, v74, v77
  v_mfma_f32_32x32x16_bf16 v[144:159], v[100:103], v[80:83], v[144:159]
  ds_read_b64_tr_b16 v[122:123], v12 offset:43008
  v_lshlrev_b32 v77, 16, v57
  v_fmac_f32 v79, v74, v77
  v_fmac_f32 v78, v73, v77
  v_and_b32 v77, s64, v57
  v_mfma_f32_32x32x16_bf16 v[160:175], v[96:99], v[84:87], v[160:175]
  ds_read_b128 v[104:107], v11 offset:1024
  v_fmac_f32 v79, v73, v77
  v_fmac_f32 v78, v72, v77
  v_lshlrev_b32 v72, 16, v48
  v_lshlrev_b32 v73, 16, v52
  v_mfma_f32_32x32x16_bf16 v[176:191], v[100:103], v[84:87], v[176:191]
  ds_read_b64_tr_b16 v[124:125], v12 offset:44032
  v_mul_f32 v78, v78, v72
  v_mul_f32 v79, v79, v73
  v_cvt_pk_bf16_f32 v14, v79, v78
  ds_write_b32 v3, v14 offset:0
  s_waitcnt lgkmcnt(5)
  v_mfma_f32_32x32x16_bf16 v[192:207], v[96:99], v[88:91], v[192:207]
  ds_read_b64_tr_b16 v[126:127], v12 offset:45056
  v_and_b32 v72, s64, v28
  v_and_b32 v73, s64, v32
  v_and_b32 v74, s64, v36
  v_and_b32 v75, s64, v40
  v_mfma_f32_32x32x16_bf16 v[208:223], v[100:103], v[88:91], v[208:223]
  ds_read_b128 v[108:111], v11 offset:5120
  v_and_b32 v76, s64, v44
  v_lshlrev_b32 v77, 16, v58
  v_mul_f32 v79, v76, v77
  v_mul_f32 v78, v75, v77
  v_mfma_f32_32x32x16_bf16 v[224:239], v[96:99], v[92:95], v[224:239]
  ds_read_b128 v[112:115], v11 offset:9216
  v_and_b32 v77, s64, v58
  v_fmac_f32 v79, v75, v77
  v_fmac_f32 v78, v74, v77
  v_lshlrev_b32 v77, 16, v59
  v_mfma_f32_32x32x16_bf16 v[240:255], v[100:103], v[92:95], v[240:255]
  ds_read_b128 v[116:119], v11 offset:13312
  v_xor_b32 v11, 49152, v11
  v_fmac_f32 v79, v74, v77
  v_fmac_f32 v78, v73, v77
  v_and_b32 v77, s64, v59
  v_fmac_f32 v79, v73, v77
  s_waitcnt lgkmcnt(6)
  v_mfma_f32_32x32x16_bf16 v[128:143], v[120:123], v[104:107], v[128:143]
  v_fmac_f32 v78, v72, v77
  v_and_b32 v72, s64, v48
  v_and_b32 v73, s64, v52
  v_mul_f32 v78, v78, v72
  s_waitcnt lgkmcnt(2)
  v_mfma_f32_32x32x16_bf16 v[144:159], v[124:127], v[104:107], v[144:159]
  s_waitcnt vmcnt(8) lgkmcnt(0)
  s_barrier
  ds_read_b64_tr_b16 v[96:97], v13 offset:17408
  ds_read_b64_tr_b16 v[98:99], v13 offset:18432
  v_mfma_f32_32x32x16_bf16 v[160:175], v[120:123], v[108:111], v[160:175]
  s_add_u32 m0, s63, 1024
  ds_read_b128 v[80:83], v8 offset:1024
  buffer_load_dwordx4 v4, s[4:7], s65 offen lds
  v_mul_f32 v79, v79, v73
  v_cvt_pk_bf16_f32 v14, v79, v78
  ds_write_b32 v3, v14 offset:128
  v_mfma_f32_32x32x16_bf16 v[176:191], v[124:127], v[108:111], v[176:191]
  ds_read_b64_tr_b16 v[100:101], v13 offset:19456
  buffer_load_dwordx4 v5, s[4:7], s65 offen offset:1024 lds
  v_lshlrev_b32 v72, 16, v29
  v_lshlrev_b32 v73, 16, v33
  v_lshlrev_b32 v74, 16, v37
  v_lshlrev_b32 v75, 16, v41
  v_mfma_f32_32x32x16_bf16 v[192:207], v[120:123], v[112:115], v[192:207]
  ds_read_b64_tr_b16 v[102:103], v13 offset:20480
  buffer_load_dwordx4 v4, s[4:7], s66 offen offset:2048 lds
  v_lshlrev_b32 v76, 16, v45
  v_lshlrev_b32 v77, 16, v60
  v_mul_f32 v79, v76, v77
  v_mul_f32 v78, v75, v77
  v_mfma_f32_32x32x16_bf16 v[208:223], v[124:127], v[112:115], v[208:223]
  ds_read_b128 v[84:87], v8 offset:5120
  buffer_load_dwordx4 v5, s[4:7], s66 offen offset:3072 lds
  s_add_u32 s65, s65, 128
  s_cmp_eq_u32 s65, 896
  s_cselect_b32 s65, 0, s65
  s_add_u32 s66, s65, 12288
  v_mfma_f32_32x32x16_bf16 v[224:239], v[120:123], v[116:119], v[224:239]
  ds_read_b128 v[88:91], v8 offset:9216
  s_add_u32 m0, s63, 33792
  v_and_b32 v77, s64, v60
  v_fmac_f32 v79, v75, v77
  v_fmac_f32 v78, v74, v77
  v_lshlrev_b32 v77, 16, v61
  v_mfma_f32_32x32x16_bf16 v[240:255], v[124:127], v[116:119], v[240:255]
  ds_read_b128 v[92:95], v8 offset:13312
  v_xor_b32 v8, 49152, v8
  buffer_load_dwordx4 v6, s[28:31], s62 offen lds
  v_fmac_f32 v79, v74, v77
  v_fmac_f32 v78, v73, v77
  v_and_b32 v77, s64, v61
  s_waitcnt lgkmcnt(6)
  v_mfma_f32_32x32x16_bf16 v[128:143], v[96:99], v[80:83], v[128:143]
  ds_read_b64_tr_b16 v[120:121], v13 offset:25600
  buffer_load_dwordx4 v6, s[32:35], s62 offen offset:2048 lds
  v_fmac_f32 v79, v73, v77
  v_fmac_f32 v78, v72, v77
  v_lshlrev_b32 v72, 16, v49
  s_waitcnt lgkmcnt(3)
  v_mfma_f32_32x32x16_bf16 v[144:159], v[100:103], v[80:83], v[144:159]
  ds_read_b64_tr_b16 v[122:123], v13 offset:26624
  buffer_load_dwordx4 v7, s[28:31], s62 offen offset:1024 lds
  v_lshlrev_b32 v73, 16, v53
  v_mul_f32 v78, v78, v72
  v_mul_f32 v79, v79, v73
  v_mfma_f32_32x32x16_bf16 v[160:175], v[96:99], v[84:87], v[160:175]
  ds_read_b128 v[104:107], v9 offset:1024
  v_cvt_pk_bf16_f32 v14, v79, v78
  ds_write_b32 v3, v14 offset:256
  v_and_b32 v72, s64, v29
  v_and_b32 v73, s64, v33
  v_mfma_f32_32x32x16_bf16 v[176:191], v[100:103], v[84:87], v[176:191]
  ds_read_b64_tr_b16 v[124:125], v13 offset:27648
  buffer_load_dwordx4 v7, s[32:35], s62 offen offset:3072 lds
  s_mul_i32 s62, s65, 1792
  v_and_b32 v74, s64, v37
  v_and_b32 v75, s64, v41
  v_and_b32 v76, s64, v45
  s_waitcnt lgkmcnt(5)
  v_mfma_f32_32x32x16_bf16 v[192:207], v[96:99], v[88:91], v[192:207]
  ds_read_b64_tr_b16 v[126:127], v13 offset:28672
  v_lshlrev_b32 v77, 16, v62
  v_mul_f32 v79, v76, v77
  v_mul_f32 v78, v75, v77
  v_and_b32 v77, s64, v62
  v_mfma_f32_32x32x16_bf16 v[208:223], v[100:103], v[88:91], v[208:223]
  ds_read_b128 v[108:111], v9 offset:5120
  v_fmac_f32 v79, v75, v77
  v_fmac_f32 v78, v74, v77
  v_lshlrev_b32 v77, 16, v63
  v_fmac_f32 v79, v74, v77
  v_mfma_f32_32x32x16_bf16 v[224:239], v[96:99], v[92:95], v[224:239]
  ds_read_b128 v[112:115], v9 offset:9216
  v_fmac_f32 v78, v73, v77
  v_and_b32 v77, s64, v63
  v_fmac_f32 v79, v73, v77
  v_fmac_f32 v78, v72, v77
  v_mfma_f32_32x32x16_bf16 v[240:255], v[100:103], v[92:95], v[240:255]
  ds_read_b128 v[116:119], v9 offset:13312
  v_xor_b32 v9, 49152, v9
  v_and_b32 v72, s64, v49
  v_and_b32 v73, s64, v53
  v_mul_f32 v78, v78, v72
  v_mul_f32 v79, v79, v73
  s_waitcnt lgkmcnt(6)
  v_mfma_f32_32x32x16_bf16 v[128:143], v[120:123], v[104:107], v[128:143]
  v_cvt_pk_bf16_f32 v14, v79, v78
  ds_write_b32 v3, v14 offset:384
  v_lshlrev_b32 v72, 16, v30
  v_lshlrev_b32 v73, 16, v34
  s_waitcnt lgkmcnt(3)
  v_mfma_f32_32x32x16_bf16 v[144:159], v[124:127], v[104:107], v[144:159]
  s_waitcnt vmcnt(12) lgkmcnt(1)
  s_barrier
  ds_read_b64_tr_b16 v[96:97], v13 offset:33792
  ds_read_b64_tr_b16 v[98:99], v13 offset:34816
  v_mfma_f32_32x32x16_bf16 v[160:175], v[120:123], v[108:111], v[160:175]
  s_add_u32 m0, s63, 66560
  ds_read_b128 v[80:83], v10 offset:1024
  buffer_load_dwordx4 v6, s[28:31], s62 offen lds
  v_lshlrev_b32 v74, 16, v38
  v_lshlrev_b32 v75, 16, v42
  v_lshlrev_b32 v76, 16, v46
  v_mfma_f32_32x32x16_bf16 v[176:191], v[124:127], v[108:111], v[176:191]
  ds_read_b64_tr_b16 v[100:101], v13 offset:35840
  buffer_load_dwordx4 v6, s[32:35], s62 offen offset:2048 lds
  v_lshlrev_b32 v77, 16, v64
  v_mul_f32 v79, v76, v77
  v_mul_f32 v78, v75, v77
  v_and_b32 v77, s64, v64
  v_mfma_f32_32x32x16_bf16 v[192:207], v[120:123], v[112:115], v[192:207]
  ds_read_b64_tr_b16 v[102:103], v13 offset:36864
  buffer_load_dwordx4 v7, s[28:31], s62 offen offset:1024 lds
  v_fmac_f32 v79, v75, v77
  v_fmac_f32 v78, v74, v77
  v_lshlrev_b32 v77, 16, v65
  v_fmac_f32 v79, v74, v77
  v_mfma_f32_32x32x16_bf16 v[208:223], v[124:127], v[112:115], v[208:223]
  ds_read_b128 v[84:87], v10 offset:5120
  buffer_load_dwordx4 v7, s[32:35], s62 offen offset:3072 lds
  s_add_u32 s62, s62, 114688
  v_fmac_f32 v78, v73, v77
  v_and_b32 v77, s64, v65
  v_fmac_f32 v79, v73, v77
  v_mfma_f32_32x32x16_bf16 v[224:239], v[120:123], v[116:119], v[224:239]
  ds_read_b128 v[88:91], v10 offset:9216
  v_fmac_f32 v78, v72, v77
  v_lshlrev_b32 v72, 16, v50
  v_lshlrev_b32 v73, 16, v54
  v_mul_f32 v78, v78, v72
  v_mfma_f32_32x32x16_bf16 v[240:255], v[124:127], v[116:119], v[240:255]
  ds_read_b128 v[92:95], v10 offset:13312
  v_xor_b32 v10, 49152, v10
  v_mul_f32 v79, v79, v73
  v_cvt_pk_bf16_f32 v14, v79, v78
  ds_write_b32 v3, v14 offset:512
  v_and_b32 v72, s64, v30
  s_waitcnt lgkmcnt(6)
  v_mfma_f32_32x32x16_bf16 v[128:143], v[96:99], v[80:83], v[128:143]
  ds_read_b64_tr_b16 v[120:121], v13 offset:41984
  v_and_b32 v73, s64, v34
  v_and_b32 v74, s64, v38
  v_and_b32 v75, s64, v42
  v_and_b32 v76, s64, v46
  s_waitcnt lgkmcnt(4)
  v_mfma_f32_32x32x16_bf16 v[144:159], v[100:103], v[80:83], v[144:159]
  ds_read_b64_tr_b16 v[122:123], v13 offset:43008
  v_lshlrev_b32 v77, 16, v66
  v_mul_f32 v79, v76, v77
  v_mul_f32 v78, v75, v77
  v_and_b32 v77, s64, v66
  v_mfma_f32_32x32x16_bf16 v[160:175], v[96:99], v[84:87], v[160:175]
  ds_read_b128 v[104:107], v11 offset:1024
  v_fmac_f32 v79, v75, v77
  v_fmac_f32 v78, v74, v77
  v_lshlrev_b32 v77, 16, v67
  v_fmac_f32 v79, v74, v77
  v_mfma_f32_32x32x16_bf16 v[176:191], v[100:103], v[84:87], v[176:191]
  ds_read_b64_tr_b16 v[124:125], v13 offset:44032
  v_fmac_f32 v78, v73, v77
  v_and_b32 v77, s64, v67
  v_fmac_f32 v79, v73, v77
  v_fmac_f32 v78, v72, v77
  s_waitcnt lgkmcnt(5)
  v_mfma_f32_32x32x16_bf16 v[192:207], v[96:99], v[88:91], v[192:207]
  ds_read_b64_tr_b16 v[126:127], v13 offset:45056
  v_and_b32 v72, s64, v50
  v_and_b32 v73, s64, v54
  v_mul_f32 v78, v78, v72
  v_mul_f32 v79, v79, v73
  v_mfma_f32_32x32x16_bf16 v[208:223], v[100:103], v[88:91], v[208:223]
  ds_read_b128 v[108:111], v11 offset:5120
  v_cvt_pk_bf16_f32 v14, v79, v78
  ds_write_b32 v3, v14 offset:640
  v_lshlrev_b32 v72, 16, v31
  v_lshlrev_b32 v73, 16, v35
  v_mfma_f32_32x32x16_bf16 v[224:239], v[96:99], v[92:95], v[224:239]
  ds_read_b128 v[112:115], v11 offset:9216
  v_lshlrev_b32 v74, 16, v39
  v_lshlrev_b32 v75, 16, v43
  v_lshlrev_b32 v76, 16, v47
  v_lshlrev_b32 v77, 16, v68
  v_mfma_f32_32x32x16_bf16 v[240:255], v[100:103], v[92:95], v[240:255]
  ds_read_b128 v[116:119], v11 offset:13312
  v_xor_b32 v11, 49152, v11
  v_mul_f32 v79, v76, v77
  v_mul_f32 v78, v75, v77
  v_and_b32 v77, s64, v68
  v_fmac_f32 v79, v75, v77
  s_waitcnt lgkmcnt(6)
  v_mfma_f32_32x32x16_bf16 v[128:143], v[120:123], v[104:107], v[128:143]
  v_fmac_f32 v78, v74, v77
  v_lshlrev_b32 v77, 16, v69
  v_fmac_f32 v79, v74, v77
  v_fmac_f32 v78, v73, v77
  s_waitcnt lgkmcnt(3)
  v_mfma_f32_32x32x16_bf16 v[144:159], v[124:127], v[104:107], v[144:159]
  s_waitcnt vmcnt(8) lgkmcnt(0)
  s_barrier
  ds_read_b64_tr_b16 v[96:97], v12 offset:17408
  ds_read_b64_tr_b16 v[98:99], v12 offset:18432
  v_mfma_f32_32x32x16_bf16 v[160:175], v[120:123], v[108:111], v[160:175]
  s_add_u32 m0, s63, 50176
  ds_read_b128 v[80:83], v8 offset:1024
  buffer_load_dwordx4 v4, s[4:7], s65 offen lds
  v_and_b32 v77, s64, v69
  v_fmac_f32 v79, v73, v77
  v_fmac_f32 v78, v72, v77
  v_mfma_f32_32x32x16_bf16 v[176:191], v[124:127], v[108:111], v[176:191]
  ds_read_b64_tr_b16 v[100:101], v12 offset:19456
  buffer_load_dwordx4 v5, s[4:7], s65 offen offset:1024 lds
  v_lshlrev_b32 v72, 16, v51
  v_lshlrev_b32 v73, 16, v55
  v_mul_f32 v78, v78, v72
  v_mul_f32 v79, v79, v73
  v_mfma_f32_32x32x16_bf16 v[192:207], v[120:123], v[112:115], v[192:207]
  ds_read_b64_tr_b16 v[102:103], v12 offset:20480
  buffer_load_dwordx4 v4, s[4:7], s66 offen offset:2048 lds
  v_cvt_pk_bf16_f32 v14, v79, v78
  ds_write_b32 v3, v14 offset:768
  v_and_b32 v72, s64, v31
  v_and_b32 v73, s64, v35
  v_mfma_f32_32x32x16_bf16 v[208:223], v[124:127], v[112:115], v[208:223]
  ds_read_b128 v[84:87], v8 offset:5120
  buffer_load_dwordx4 v5, s[4:7], s66 offen offset:3072 lds
  s_add_u32 s65, s65, 128
  s_cmp_eq_u32 s65, 896
  s_cselect_b32 s65, 0, s65
  s_add_u32 s66, s65, 12288
  v_mfma_f32_32x32x16_bf16 v[224:239], v[120:123], v[116:119], v[224:239]
  ds_read_b128 v[88:91], v8 offset:9216
  s_add_u32 m0, s63, 82944
  v_and_b32 v74, s64, v39
  v_and_b32 v75, s64, v43
  v_and_b32 v76, s64, v47
  v_lshlrev_b32 v77, 16, v70
  v_mfma_f32_32x32x16_bf16 v[240:255], v[124:127], v[116:119], v[240:255]
  ds_read_b128 v[92:95], v8 offset:13312
  v_xor_b32 v8, 49152, v8
  buffer_load_dwordx4 v6, s[28:31], s62 offen lds
  v_mul_f32 v79, v76, v77
  v_mul_f32 v78, v75, v77
  v_and_b32 v77, s64, v70
  s_waitcnt lgkmcnt(6)
  v_mfma_f32_32x32x16_bf16 v[128:143], v[96:99], v[80:83], v[128:143]
  ds_read_b64_tr_b16 v[120:121], v12 offset:25600
  buffer_load_dwordx4 v6, s[32:35], s62 offen offset:2048 lds
  v_fmac_f32 v79, v75, v77
  v_fmac_f32 v78, v74, v77
  v_lshlrev_b32 v77, 16, v71
  s_waitcnt lgkmcnt(3)
  v_mfma_f32_32x32x16_bf16 v[144:159], v[100:103], v[80:83], v[144:159]
  ds_read_b64_tr_b16 v[122:123], v12 offset:26624
  buffer_load_dwordx4 v7, s[28:31], s62 offen offset:1024 lds
  v_fmac_f32 v79, v74, v77
  v_fmac_f32 v78, v73, v77
  v_and_b32 v77, s64, v71
  v_mfma_f32_32x32x16_bf16 v[160:175], v[96:99], v[84:87], v[160:175]
  ds_read_b128 v[104:107], v9 offset:1024
  v_fmac_f32 v79, v73, v77
  v_fmac_f32 v78, v72, v77
  v_and_b32 v72, s64, v51
  v_and_b32 v73, s64, v55
  v_mfma_f32_32x32x16_bf16 v[176:191], v[100:103], v[84:87], v[176:191]
  ds_read_b64_tr_b16 v[124:125], v12 offset:27648
  buffer_load_dwordx4 v7, s[32:35], s62 offen offset:3072 lds
  s_mul_i32 s62, s65, 1792
  v_mul_f32 v78, v78, v72
  v_mul_f32 v79, v79, v73
  v_cvt_pk_bf16_f32 v14, v79, v78
  s_waitcnt lgkmcnt(4)
  v_mfma_f32_32x32x16_bf16 v[192:207], v[96:99], v[88:91], v[192:207]
  ds_read_b64_tr_b16 v[126:127], v12 offset:28672
  ds_write_b32 v3, v14 offset:896
  v_accvgpr_read_b32 v72, a233
  v_accvgpr_read_b32 v73, a234
  v_accvgpr_read_b32 v41, a235
  v_mfma_f32_32x32x16_bf16 v[208:223], v[100:103], v[88:91], v[208:223]
  ds_read_b128 v[108:111], v9 offset:5120
  v_accvgpr_read_b32 v42, a236
  v_lshlrev_b32 v43, 7, v1
  v_mov_b32 v44, 1
  s_add_u32 s1, s68, 32768
  v_mfma_f32_32x32x16_bf16 v[224:239], v[96:99], v[92:95], v[224:239]
  ds_read_b128 v[112:115], v9 offset:9216
  v_mfma_f32_32x32x16_bf16 v[240:255], v[100:103], v[92:95], v[240:255]
  ds_read_b128 v[116:119], v9 offset:13312
  v_xor_b32 v9, 49152, v9
  s_waitcnt lgkmcnt(6)
  v_mfma_f32_32x32x16_bf16 v[128:143], v[120:123], v[104:107], v[128:143]
  buffer_load_dword v0, off, s[44:47], 0 sc1
  s_waitcnt lgkmcnt(2)
  v_mfma_f32_32x32x16_bf16 v[144:159], v[124:127], v[104:107], v[144:159]
  s_waitcnt vmcnt(13) lgkmcnt(0)
  s_barrier
  ds_read_b64_tr_b16 v[96:97], v12 offset:33792
  ds_read_b64_tr_b16 v[98:99], v12 offset:34816
  v_mfma_f32_32x32x16_bf16 v[160:175], v[120:123], v[108:111], v[160:175]
  s_add_u32 m0, s63, 17408
  ds_read_b128 v[80:83], v10 offset:1024
  buffer_load_dwordx4 v6, s[28:31], s62 offen lds
  ds_read_b128 v[64:67], v72
  ds_read_b128 v[68:71], v72 offset:1040
  v_mfma_f32_32x32x16_bf16 v[176:191], v[124:127], v[108:111], v[176:191]
  ds_read_b64_tr_b16 v[100:101], v12 offset:35840
  buffer_load_dwordx4 v6, s[32:35], s62 offen offset:2048 lds
  v_mfma_f32_32x32x16_bf16 v[192:207], v[120:123], v[112:115], v[192:207]
  ds_read_b64_tr_b16 v[102:103], v12 offset:36864
  buffer_load_dwordx4 v7, s[28:31], s62 offen offset:1024 lds
  v_mfma_f32_32x32x16_bf16 v[208:223], v[124:127], v[112:115], v[208:223]
  ds_read_b128 v[84:87], v10 offset:5120
  buffer_load_dwordx4 v7, s[32:35], s62 offen offset:3072 lds
  s_add_u32 s62, s62, 114688
  v_mfma_f32_32x32x16_bf16 v[224:239], v[120:123], v[116:119], v[224:239]
  ds_read_b128 v[88:91], v10 offset:9216
  s_waitcnt lgkmcnt(4)
  buffer_store_dwordx4 v[64:67], v73, s[48:51], s68 offen sc1
  v_mfma_f32_32x32x16_bf16 v[240:255], v[124:127], v[116:119], v[240:255]
  ds_read_b128 v[92:95], v10 offset:13312
  v_xor_b32 v10, 49152, v10
  buffer_store_dwordx4 v[68:71], v73, s[48:51], s1 offen sc1
  v_mfma_f32_32x32x16_bf16 v[128:143], v[96:99], v[80:83], v[128:143]
  ds_read_b64_tr_b16 v[120:121], v12 offset:41984
  s_waitcnt lgkmcnt(3)
  v_mfma_f32_32x32x16_bf16 v[144:159], v[100:103], v[80:83], v[144:159]
  ds_read_b64_tr_b16 v[122:123], v12 offset:43008
  v_mfma_f32_32x32x16_bf16 v[160:175], v[96:99], v[84:87], v[160:175]
  ds_read_b128 v[104:107], v11 offset:1024
  v_mfma_f32_32x32x16_bf16 v[176:191], v[100:103], v[84:87], v[176:191]
  ds_read_b64_tr_b16 v[124:125], v12 offset:44032
  s_waitcnt lgkmcnt(4)
  v_mfma_f32_32x32x16_bf16 v[192:207], v[96:99], v[88:91], v[192:207]
  ds_read_b64_tr_b16 v[126:127], v12 offset:45056
  v_mfma_f32_32x32x16_bf16 v[208:223], v[100:103], v[88:91], v[208:223]
  ds_read_b128 v[108:111], v11 offset:5120
  v_mfma_f32_32x32x16_bf16 v[224:239], v[96:99], v[92:95], v[224:239]
  ds_read_b128 v[112:115], v11 offset:9216
  v_mfma_f32_32x32x16_bf16 v[240:255], v[100:103], v[92:95], v[240:255]
  ds_read_b128 v[116:119], v11 offset:13312
  v_xor_b32 v11, 49152, v11
  s_waitcnt lgkmcnt(5)
  v_mfma_f32_32x32x16_bf16 v[128:143], v[120:123], v[104:107], v[128:143]
  s_waitcnt lgkmcnt(2)
  v_mfma_f32_32x32x16_bf16 v[144:159], v[124:127], v[104:107], v[144:159]
  s_waitcnt vmcnt(6) lgkmcnt(0)
  s_barrier
  v_readfirstlane_b32 s57, v0
  s_nop 1
  s_cmp_ge_u32 s57, 1
  s_cbranch_scc1 Lok1
  s_mov_b32 s58, 100000
Lsp1:
  s_sleep 1
  buffer_load_dword v0, off, s[44:47], 0 sc1
  s_waitcnt vmcnt(0)
  v_readfirstlane_b32 s57, v0
  s_nop 1
  s_cmp_ge_u32 s57, 1
  s_cbranch_scc1 Lok1
  s_sub_u32 s58, s58, 1
  s_cmp_lg_u32 s58, 0
  s_cbranch_scc1 Lsp1
Lok1:
  ds_read_b64_tr_b16 v[96:97], v13 offset:17408
  ds_read_b64_tr_b16 v[98:99], v13 offset:18432
  v_mfma_f32_32x32x16_bf16 v[160:175], v[120:123], v[108:111], v[160:175]
  s_add_u32 m0, s63, 1024
  ds_read_b128 v[80:83], v8 offset:1024
  buffer_load_dwordx4 v4, s[4:7], s65 offen lds
  v_mfma_f32_32x32x16_bf16 v[176:191], v[124:127], v[108:111], v[176:191]
  ds_read_b64_tr_b16 v[100:101], v13 offset:19456
  buffer_load_dwordx4 v5, s[4:7], s65 offen offset:1024 lds
  v_mfma_f32_32x32x16_bf16 v[192:207], v[120:123], v[112:115], v[192:207]
  ds_read_b64_tr_b16 v[102:103], v13 offset:20480
  buffer_load_dwordx4 v4, s[4:7], s66 offen offset:2048 lds
  v_mfma_f32_32x32x16_bf16 v[208:223], v[124:127], v[112:115], v[208:223]
  ds_read_b128 v[84:87], v8 offset:5120
  buffer_load_dwordx4 v5, s[4:7], s66 offen offset:3072 lds
  s_add_u32 s65, s65, 128
  s_cmp_eq_u32 s65, 896
  s_cselect_b32 s65, 0, s65
  s_add_u32 s66, s65, 12288
  v_mfma_f32_32x32x16_bf16 v[224:239], v[120:123], v[116:119], v[224:239]
  ds_read_b128 v[88:91], v8 offset:9216
  s_add_u32 m0, s63, 33792
  v_mfma_f32_32x32x16_bf16 v[240:255], v[124:127], v[116:119], v[240:255]
  ds_read_b128 v[92:95], v8 offset:13312
  v_xor_b32 v8, 49152, v8
  buffer_load_dwordx4 v6, s[28:31], s62 offen lds
  s_waitcnt lgkmcnt(5)
  v_mfma_f32_32x32x16_bf16 v[128:143], v[96:99], v[80:83], v[128:143]
  ds_read_b64_tr_b16 v[120:121], v13 offset:25600
  buffer_load_dwordx4 v6, s[32:35], s62 offen offset:2048 lds
  s_waitcnt lgkmcnt(3)
  v_mfma_f32_32x32x16_bf16 v[144:159], v[100:103], v[80:83], v[144:159]
  ds_read_b64_tr_b16 v[122:123], v13 offset:26624
  buffer_load_dwordx4 v7, s[28:31], s62 offen offset:1024 lds
  v_mfma_f32_32x32x16_bf16 v[160:175], v[96:99], v[84:87], v[160:175]
  ds_read_b128 v[104:107], v9 offset:1024
  v_mfma_f32_32x32x16_bf16 v[176:191], v[100:103], v[84:87], v[176:191]
  ds_read_b64_tr_b16 v[124:125], v13 offset:27648
  buffer_load_dwordx4 v7, s[32:35], s62 offen offset:3072 lds
  s_mul_i32 s62, s65, 1792
  v_add_u32 v5, 6144, v16
  v_add_u32 v6, 12288, v16
  v_add_u32 v7, 18432, v16
  s_waitcnt lgkmcnt(4)
  v_mfma_f32_32x32x16_bf16 v[192:207], v[96:99], v[88:91], v[192:207]
  ds_read_b64_tr_b16 v[126:127], v13 offset:28672
  s_movk_i32 s65, 128
  buffer_load_dword v0, off, s[44:47], s65 sc1
  v_mfma_f32_32x32x16_bf16 v[208:223], v[100:103], v[88:91], v[208:223]
  ds_read_b128 v[108:111], v9 offset:5120
  v_mfma_f32_32x32x16_bf16 v[224:239], v[96:99], v[92:95], v[224:239]
  ds_read_b128 v[112:115], v9 offset:9216
  v_mfma_f32_32x32x16_bf16 v[240:255], v[100:103], v[92:95], v[240:255]
  ds_read_b128 v[116:119], v9 offset:13312
  v_xor_b32 v9, 49152, v9
  s_waitcnt lgkmcnt(5)
  v_mfma_f32_32x32x16_bf16 v[128:143], v[120:123], v[104:107], v[128:143]
  s_waitcnt lgkmcnt(2)
  v_mfma_f32_32x32x16_bf16 v[144:159], v[124:127], v[104:107], v[144:159]
  s_waitcnt vmcnt(9) lgkmcnt(0)
  s_barrier
  s_cmp_lg_u32 s52, 0
  s_cbranch_scc1 Lsg2
  s_andn2_b32 s59, s72, 0x380
  s_mov_b64 exec, 255
  buffer_atomic_add v44, v43, s[48:51], s59 offen sc1
  s_mov_b64 exec, -1
Lsg2:
  ds_read_b64_tr_b16 v[96:97], v13 offset:33792
  ds_read_b64_tr_b16 v[98:99], v13 offset:34816
  v_mfma_f32_32x32x16_bf16 v[160:175], v[120:123], v[108:111], v[160:175]
  s_add_u32 m0, s63, 66560
  ds_read_b128 v[80:83], v10 offset:1024
  buffer_load_dwordx4 v16, s[36:39], s67 offen lds
  v_mfma_f32_32x32x16_bf16 v[176:191], v[124:127], v[108:111], v[176:191]
  ds_read_b64_tr_b16 v[100:101], v13 offset:35840
  buffer_load_dwordx4 v5, s[36:39], s67 offen offset:1024 lds
  v_mfma_f32_32x32x16_bf16 v[192:207], v[120:123], v[112:115], v[192:207]
  ds_read_b64_tr_b16 v[102:103], v13 offset:36864
  v_mfma_f32_32x32x16_bf16 v[208:223], v[124:127], v[112:115], v[208:223]
  ds_read_b128 v[84:87], v10 offset:5120
  buffer_load_dwordx4 v6, s[36:39], s67 offen offset:2048 lds
  v_mfma_f32_32x32x16_bf16 v[224:239], v[120:123], v[116:119], v[224:239]
  ds_read_b128 v[88:91], v10 offset:9216
  v_mfma_f32_32x32x16_bf16 v[240:255], v[124:127], v[116:119], v[240:255]
  ds_read_b128 v[92:95], v10 offset:13312
  v_xor_b32 v10, 49152, v10
  buffer_load_dwordx4 v7, s[36:39], s67 offen offset:3072 lds
  s_add_u32 s67, s67, 28672
  s_add_u32 m0, s70, 99724
  s_waitcnt lgkmcnt(5)
  v_mfma_f32_32x32x16_bf16 v[128:143], v[96:99], v[80:83], v[128:143]
  ds_read_b64_tr_b16 v[120:121], v13 offset:41984
  s_waitcnt lgkmcnt(3)
  v_mfma_f32_32x32x16_bf16 v[144:159], v[100:103], v[80:83], v[144:159]
  ds_read_b64_tr_b16 v[122:123], v13 offset:43008
  buffer_load_dwordx4 v2, s[20:23], s69 offen lds
  v_mfma_f32_32x32x16_bf16 v[160:175], v[96:99], v[84:87], v[160:175]
  ds_read_b128 v[104:107], v11 offset:1024
  buffer_load_dwordx4 v2, s[20:23], s69 offen offset:1024 lds
  v_mfma_f32_32x32x16_bf16 v[176:191], v[100:103], v[84:87], v[176:191]
  ds_read_b64_tr_b16 v[124:125], v13 offset:44032
  s_waitcnt lgkmcnt(4)
  v_mfma_f32_32x32x16_bf16 v[192:207], v[96:99], v[88:91], v[192:207]
  ds_read_b64_tr_b16 v[126:127], v13 offset:45056
  buffer_load_dwordx4 v2, s[20:23], s69 offen offset:2048 lds
  v_mfma_f32_32x32x16_bf16 v[208:223], v[100:103], v[88:91], v[208:223]
  ds_read_b128 v[108:111], v11 offset:5120
  v_mfma_f32_32x32x16_bf16 v[224:239], v[96:99], v[92:95], v[224:239]
  ds_read_b128 v[112:115], v11 offset:9216
  buffer_load_dwordx4 v2, s[20:23], s69 offen offset:3072 lds
  s_add_u32 m0, s70, 104360
  v_mfma_f32_32x32x16_bf16 v[240:255], v[100:103], v[92:95], v[240:255]
  ds_read_b128 v[116:119], v11 offset:13312
  v_xor_b32 v11, 49152, v11
  s_waitcnt lgkmcnt(5)
  v_mfma_f32_32x32x16_bf16 v[128:143], v[120:123], v[104:107], v[128:143]
  buffer_load_dwordx4 v2, s[20:23], s69 offen lds
  s_waitcnt lgkmcnt(2)
  v_mfma_f32_32x32x16_bf16 v[144:159], v[124:127], v[104:107], v[144:159]
  s_waitcnt vmcnt(14) lgkmcnt(0)
  s_barrier
  ds_read_b64_tr_b16 v[96:97], v12 offset:17408
  ds_read_b64_tr_b16 v[98:99], v12 offset:18432
  v_mfma_f32_32x32x16_bf16 v[160:175], v[120:123], v[108:111], v[160:175]
  ds_read_b128 v[80:83], v8 offset:1024
  buffer_load_dwordx4 v2, s[20:23], s69 offen offset:1024 lds
  v_mfma_f32_32x32x16_bf16 v[176:191], v[124:127], v[108:111], v[176:191]
  ds_read_b64_tr_b16 v[100:101], v12 offset:19456
  buffer_load_dwordx4 v2, s[20:23], s69 offen offset:2048 lds
  v_mfma_f32_32x32x16_bf16 v[192:207], v[120:123], v[112:115], v[192:207]
  ds_read_b64_tr_b16 v[102:103], v12 offset:20480
  v_mfma_f32_32x32x16_bf16 v[208:223], v[124:127], v[112:115], v[208:223]
  ds_read_b128 v[84:87], v8 offset:5120
  buffer_load_dwordx4 v2, s[20:23], s69 offen offset:3072 lds
  v_mfma_f32_32x32x16_bf16 v[224:239], v[120:123], v[116:119], v[224:239]
  ds_read_b128 v[88:91], v8 offset:9216
  v_mfma_f32_32x32x16_bf16 v[240:255], v[124:127], v[116:119], v[240:255]
  ds_read_b128 v[92:95], v8 offset:13312
  v_xor_b32 v8, 49152, v8
  s_waitcnt lgkmcnt(5)
  v_mfma_f32_32x32x16_bf16 v[128:143], v[96:99], v[80:83], v[128:143]
  ds_read_b64_tr_b16 v[120:121], v12 offset:25600
  s_waitcnt vmcnt(12)
  v_readfirstlane_b32 s57, v0
  s_nop 1
  s_cmp_ge_u32 s57, 32
  s_cbranch_scc1 Lok8
  s_mov_b32 s58, 100000
Lsp8:
  s_sleep 1
  buffer_load_dword v0, off, s[44:47], s65 sc1
  s_waitcnt vmcnt(0)
  v_readfirstlane_b32 s57, v0
  s_nop 1
  s_cmp_ge_u32 s57, 32
  s_cbranch_scc1 Lok8
  s_sub_u32 s58, s58, 1
  s_cmp_lg_u32 s58, 0
  s_cbranch_scc1 Lsp8
Lok8:
  s_waitcnt lgkmcnt(3)
  v_mfma_f32_32x32x16_bf16 v[144:159], v[100:103], v[80:83], v[144:159]
  ds_read_b64_tr_b16 v[122:123], v12 offset:26624
  buffer_load_dwordx2 v[28:29], v41, s[48:51], s79 offen offset:0 sc1
  buffer_load_dwordx2 v[30:31], v41, s[48:51], s79 offen offset:256 sc1
  v_mfma_f32_32x32x16_bf16 v[160:175], v[96:99], v[84:87], v[160:175]
  ds_read_b128 v[104:107], v9 offset:1024
  buffer_load_dwordx2 v[32:33], v41, s[48:51], s79 offen offset:512 sc1
  v_mfma_f32_32x32x16_bf16 v[176:191], v[100:103], v[84:87], v[176:191]
  ds_read_b64_tr_b16 v[124:125], v12 offset:27648
  buffer_load_dwordx2 v[34:35], v41, s[48:51], s79 offen offset:768 sc1
  s_mov_b32 s59, 49152
  buffer_load_dwordx2 v[36:37], v42, s[48:51], s59 offen sc1
  s_waitcnt lgkmcnt(4)
  v_mfma_f32_32x32x16_bf16 v[192:207], v[96:99], v[88:91], v[192:207]
  ds_read_b64_tr_b16 v[126:127], v12 offset:28672
  s_mov_b32 s59, 63488
  buffer_load_dwordx2 v[38:39], v42, s[48:51], s59 offen sc1
  s_add_u32 m0, s63, 82944
  v_mfma_f32_32x32x16_bf16 v[208:223], v[100:103], v[88:91], v[208:223]
  ds_read_b128 v[108:111], v9 offset:5120
  buffer_load_dwordx4 v16, s[36:39], s67 offen lds
  v_mfma_f32_32x32x16_bf16 v[224:239], v[96:99], v[92:95], v[224:239]
  ds_read_b128 v[112:115], v9 offset:9216
  v_mfma_f32_32x32x16_bf16 v[240:255], v[100:103], v[92:95], v[240:255]
  ds_read_b128 v[116:119], v9 offset:13312
  v_xor_b32 v9, 49152, v9
  buffer_load_dwordx4 v5, s[36:39], s67 offen offset:1024 lds
  s_waitcnt lgkmcnt(5)
  v_mfma_f32_32x32x16_bf16 v[128:143], v[120:123], v[104:107], v[128:143]
  buffer_load_dwordx4 v6, s[36:39], s67 offen offset:2048 lds
  s_waitcnt lgkmcnt(2)
  v_mfma_f32_32x32x16_bf16 v[144:159], v[124:127], v[104:107], v[144:159]
  s_waitcnt lgkmcnt(0)
  s_barrier
  ds_read_b64_tr_b16 v[96:97], v12 offset:33792
  ds_read_b64_tr_b16 v[98:99], v12 offset:34816
  v_mfma_f32_32x32x16_bf16 v[160:175], v[120:123], v[108:111], v[160:175]
  ds_read_b128 v[80:83], v10 offset:1024
  buffer_load_dwordx4 v7, s[36:39], s67 offen offset:3072 lds
  s_add_u32 s67, s67, 28672
  s_add_u32 m0, s63, 50176
  v_mfma_f32_32x32x16_bf16 v[176:191], v[124:127], v[108:111], v[176:191]
  ds_read_b64_tr_b16 v[100:101], v12 offset:35840
  v_mfma_f32_32x32x16_bf16 v[192:207], v[120:123], v[112:115], v[192:207]
  ds_read_b64_tr_b16 v[102:103], v12 offset:36864
  buffer_load_dwordx4 v16, s[36:39], s67 offen lds
  v_mfma_f32_32x32x16_bf16 v[208:223], v[124:127], v[112:115], v[208:223]
  ds_read_b128 v[84:87], v10 offset:5120
  v_mfma_f32_32x32x16_bf16 v[224:239], v[120:123], v[116:119], v[224:239]
  ds_read_b128 v[88:91], v10 offset:9216
  buffer_load_dwordx4 v5, s[36:39], s67 offen offset:1024 lds
  v_mfma_f32_32x32x16_bf16 v[240:255], v[124:127], v[116:119], v[240:255]
  ds_read_b128 v[92:95], v10 offset:13312
  v_xor_b32 v10, 49152, v10
  s_waitcnt lgkmcnt(5)
  v_mfma_f32_32x32x16_bf16 v[128:143], v[96:99], v[80:83], v[128:143]
  ds_read_b64_tr_b16 v[120:121], v12 offset:41984
  buffer_load_dwordx4 v6, s[36:39], s67 offen offset:2048 lds
  s_waitcnt lgkmcnt(3)
  v_mfma_f32_32x32x16_bf16 v[144:159], v[100:103], v[80:83], v[144:159]
  ds_read_b64_tr_b16 v[122:123], v12 offset:43008
  buffer_load_dwordx4 v7, s[36:39], s67 offen offset:3072 lds
  s_add_u32 s67, s67, 28672
  s_waitcnt vmcnt(22)
  ds_read_b64_tr_b16 a[0:1], v19 offset:17408
  v_mfma_f32_32x32x16_bf16 v[160:175], v[96:99], v[84:87], v[160:175]
  ds_read_b128 v[104:107], v11 offset:1024
  ds_read_b64_tr_b16 a[2:3], v19 offset:18432
  ds_read_b64_tr_b16 a[4:5], v20 offset:17408
  ds_read_b64_tr_b16 a[6:7], v20 offset:18432
  ds_read_b64_tr_b16 a[8:9], v19 offset:19456
  ds_read_b64_tr_b16 a[10:11], v19 offset:20480
  v_mfma_f32_32x32x16_bf16 v[176:191], v[100:103], v[84:87], v[176:191]
  ds_read_b64_tr_b16 v[124:125], v12 offset:44032
  ds_read_b64_tr_b16 a[12:13], v20 offset:19456
  ds_read_b64_tr_b16 a[14:15], v20 offset:20480
  s_waitcnt lgkmcnt(12)
  v_mfma_f32_32x32x16_bf16 v[192:207], v[96:99], v[88:91], v[192:207]
  ds_read_b64_tr_b16 v[126:127], v12 offset:45056
  v_mfma_f32_32x32x16_bf16 v[208:223], v[100:103], v[88:91], v[208:223]
  ds_read_b128 v[108:111], v11 offset:5120
  v_mfma_f32_32x32x16_bf16 v[224:239], v[96:99], v[92:95], v[224:239]
  ds_read_b128 v[112:115], v11 offset:9216
  buffer_load_dword v0, off, s[48:51], s72 sc1
  s_add_u32 m0, s63, 17408
  s_nop 0
  buffer_load_dwordx4 v16, s[36:39], s67 offen lds
  v_mfma_f32_32x32x16_bf16 v[240:255], v[100:103], v[92:95], v[240:255]
  ds_read_b128 v[116:119], v11 offset:13312
  v_xor_b32 v11, 49152, v11
  s_waitcnt lgkmcnt(12)
  v_mfma_f32_32x32x16_bf16 v[128:143], v[120:123], v[104:107], v[128:143]
  s_waitcnt vmcnt(10)
  v_cmp_gt_u32 vcc, 32, v1
  v_accvgpr_read_b32 v46, a237
  v_mov_b32 v47, 0
  v_cndmask_b32 v48, 0, v28, vcc
  s_waitcnt lgkmcnt(2)
  v_mfma_f32_32x32x16_bf16 v[144:159], v[124:127], v[104:107], v[144:159]
  s_waitcnt lgkmcnt(0)
  s_barrier
  v_cndmask_b32 v49, 0, v28, vcc
  v_cndmask_b32 v50, 0, v30, vcc
  v_mfma_f32_32x32x16_bf16 v[160:175], v[120:123], v[108:111], v[160:175]
  v_cndmask_b32 v51, 0, v30, vcc
  v_cndmask_b32 v52, 0, v32, vcc
  v_cndmask_b32 v53, 0, v32, vcc
  v_cndmask_b32 v54, 0, v34, vcc
  v_cndmask_b32 v55, 0, v34, vcc
  buffer_load_dwordx4 v5, s[36:39], s67 offen offset:1024 lds
  v_mfma_f32_32x32x16_bf16 v[176:191], v[124:127], v[108:111], v[176:191]
  buffer_load_dwordx4 v6, s[36:39], s67 offen offset:2048 lds
  v_mfma_f32_32x32x16_bf16 v[192:207], v[120:123], v[112:115], v[192:207]
  buffer_load_dwordx4 v7, s[36:39], s67 offen offset:3072 lds
  s_add_u32 s67, s67, 28672
  s_add_u32 m0, s63, 33792
  v_mfma_f32_32x32x16_bf16 v[208:223], v[124:127], v[112:115], v[208:223]
  v_mfma_f32_32x32x16_bf16 v[224:239], v[120:123], v[116:119], v[224:239]
  buffer_load_dwordx4 v16, s[36:39], s67 offen lds
  v_mfma_f32_32x32x16_bf16 v[240:255], v[124:127], v[116:119], v[240:255]
  buffer_load_dwordx4 v5, s[36:39], s67 offen offset:1024 lds
  v_mfma_f32_32x32x8_bf16 v[128:143], v[36:37], v[48:49], v[128:143]
  v_rcp_f32 v57, v29
  v_mul_f32 v56, v29, v29
  v_mul_f32 v57, 0xbfb8aa3b, v57
  v_rcp_f32 v59, v31
  v_mfma_f32_32x32x8_bf16 v[144:159], v[38:39], v[48:49], v[144:159]
  v_mul_f32 v58, v31, v31
  v_mul_f32 v59, 0xbfb8aa3b, v59
  v_rcp_f32 v61, v33
  v_mul_f32 v60, v33, v33
  v_mul_f32 v61, 0xbfb8aa3b, v61
  v_mfma_f32_32x32x8_bf16 v[192:207], v[36:37], v[52:53], v[192:207]
  v_rcp_f32 v63, v35
  v_mul_f32 v62, v35, v35
  v_mul_f32 v63, 0xbfb8aa3b, v63
  s_waitcnt vmcnt(11)
  ds_read_b64_tr_b16 a[16:17], v19 offset:33792
  v_mfma_f32_32x32x8_bf16 v[208:223], v[38:39], v[52:53], v[208:223]
  ds_read_b64_tr_b16 a[18:19], v19 offset:34816
  ds_read_b64_tr_b16 a[20:21], v20 offset:33792
  ds_read_b64_tr_b16 a[22:23], v20 offset:34816
  ds_read_b64_tr_b16 a[24:25], v19 offset:35840
  ds_read_b64_tr_b16 a[26:27], v19 offset:36864
  ds_read_b64_tr_b16 a[28:29], v20 offset:35840
  v_mfma_f32_32x32x8_bf16 v[160:175], v[36:37], v[50:51], v[160:175]
  ds_read_b64_tr_b16 a[30:31], v20 offset:36864
  buffer_load_dwordx4 v6, s[36:39], s67 offen offset:2048 lds
  v_mfma_f32_32x32x8_bf16 v[176:191], v[38:39], v[50:51], v[176:191]
  buffer_load_dwordx4 v7, s[36:39], s67 offen offset:3072 lds
  s_add_u32 s67, s67, 28672
  v_mfma_f32_32x32x8_bf16 v[224:239], v[36:37], v[54:55], v[224:239]
  s_waitcnt vmcnt(8)
  s_add_u32 s69, s69, 131072
  v_readfirstlane_b32 s57, v0
  s_nop 1
  s_cmp_ge_u32 s57, 32
  s_cselect_b32 s70, s69, 49152
  buffer_load_dwordx4 v[72:75], v23, s[48:51], s70 offen offset:0 sc1
  v_mfma_f32_32x32x8_bf16 v[240:255], v[38:39], v[54:55], v[240:255]
  v_pk_mul_f32 v[64:65], v[128:129], v[56:57] op_sel:[0,1] op_sel_hi:[1,1]
  buffer_load_dwordx4 v[76:79], v23, s[48:51], s70 offen offset:1024 sc1
  s_add_u32 m0, s63, 1024
  v_exp_f32 v64, v64
  v_pk_mul_f32 v[128:129], v[128:129], v[144:145]
  v_pk_mul_f32 v[66:67], v[130:131], v[56:57] op_sel:[0,1] op_sel_hi:[1,1]
  v_exp_f32 v65, v65
  buffer_load_dwordx4 v16, s[36:39], s67 offen lds
  v_pk_fma_f32 v[64:65], v[64:65], v[56:57], v[56:57] op_sel:[0,0,0] op_sel_hi:[1,0,0]
  v_exp_f32 v66, v66
  v_pk_mul_f32 v[130:131], v[130:131], v[146:147]
  v_rcp_f32 v64, v64
  v_pk_mul_f32 v[68:69], v[132:133], v[56:57] op_sel:[0,1] op_sel_hi:[1,1]
  v_rcp_f32 v65, v65
  v_exp_f32 v67, v67
  v_pk_mul_f32 v[128:129], v[128:129], v[64:65]
  buffer_load_dwordx4 v5, s[36:39], s67 offen offset:1024 lds
  v_pk_fma_f32 v[66:67], v[66:67], v[56:57], v[56:57] op_sel:[0,0,0] op_sel_hi:[1,0,0]
  v_exp_f32 v68, v68
  v_pk_mul_f32 v[132:133], v[132:133], v[148:149]
  v_rcp_f32 v66, v66
  v_pk_mul_f32 v[64:65], v[134:135], v[56:57] op_sel:[0,1] op_sel_hi:[1,1]
  v_rcp_f32 v67, v67
  v_cvt_pk_bf16_f32 v144, v128, v129
  v_exp_f32 v69, v69
  v_pk_mul_f32 v[130:131], v[130:131], v[66:67]
  buffer_load_dwordx4 v6, s[36:39], s67 offen offset:2048 lds
  v_pk_fma_f32 v[68:69], v[68:69], v[56:57], v[56:57] op_sel:[0,0,0] op_sel_hi:[1,0,0]
  v_exp_f32 v64, v64
  v_pk_mul_f32 v[134:135], v[134:135], v[150:151]
  v_rcp_f32 v68, v68
  v_pk_mul_f32 v[66:67], v[136:137], v[56:57] op_sel:[0,1] op_sel_hi:[1,1]
  v_rcp_f32 v69, v69
  v_cvt_pk_bf16_f32 v145, v130, v131
  v_exp_f32 v65, v65
  v_pk_mul_f32 v[132:133], v[132:133], v[68:69]
  buffer_load_dwordx4 v7, s[36:39], s67 offen offset:3072 lds
  s_add_u32 s67, s67, 28672
  v_pk_fma_f32 v[64:65], v[64:65], v[56:57], v[56:57] op_sel:[0,0,0] op_sel_hi:[1,0,0]
  v_exp_f32 v66, v66
  v_pk_mul_f32 v[136:137], v[136:137], v[152:153]
  v_rcp_f32 v64, v64
  v_pk_mul_f32 v[68:69], v[138:139], v[56:57] op_sel:[0,1] op_sel_hi:[1,1]
  v_rcp_f32 v65, v65
  v_cvt_pk_bf16_f32 v146, v132, v133
  v_exp_f32 v67, v67
  v_pk_mul_f32 v[134:135], v[134:135], v[64:65]
  v_pk_fma_f32 v[66:67], v[66:67], v[56:57], v[56:57] op_sel:[0,0,0] op_sel_hi:[1,0,0]
  v_exp_f32 v68, v68
  v_pk_mul_f32 v[138:139], v[138:139], v[154:155]
  v_rcp_f32 v66, v66
  v_pk_mul_f32 v[64:65], v[140:141], v[56:57] op_sel:[0,1] op_sel_hi:[1,1]
  v_rcp_f32 v67, v67
  v_cvt_pk_bf16_f32 v147, v134, v135
  buffer_store_dwordx4 v[144:147], v2, s[48:51], s75 offen offset:0 sc1
  v_exp_f32 v69, v69
  v_pk_mul_f32 v[136:137], v[136:137], v[66:67]
  v_pk_fma_f32 v[68:69], v[68:69], v[56:57], v[56:57] op_sel:[0,0,0] op_sel_hi:[1,0,0]
  v_exp_f32 v64, v64
  v_pk_mul_f32 v[140:141], v[140:141], v[156:157]
  v_rcp_f32 v68, v68
  v_pk_mul_f32 v[66:67], v[142:143], v[56:57] op_sel:[0,1] op_sel_hi:[1,1]
  v_rcp_f32 v69, v69
  v_cvt_pk_bf16_f32 v148, v136, v137
  v_exp_f32 v65, v65
  v_pk_mul_f32 v[138:139], v[138:139], v[68:69]
  v_pk_fma_f32 v[64:65], v[64:65], v[56:57], v[56:57] op_sel:[0,0,0] op_sel_hi:[1,0,0]
  v_exp_f32 v66, v66
  v_pk_mul_f32 v[142:143], v[142:143], v[158:159]
  v_rcp_f32 v64, v64
  v_pk_mul_f32 v[68:69], v[192:193], v[60:61] op_sel:[0,1] op_sel_hi:[1,1]
  v_rcp_f32 v65, v65
  v_cvt_pk_bf16_f32 v149, v138, v139
  v_exp_f32 v67, v67
  v_pk_mul_f32 v[140:141], v[140:141], v[64:65]
  v_pk_fma_f32 v[66:67], v[66:67], v[56:57], v[56:57] op_sel:[0,0,0] op_sel_hi:[1,0,0]
  v_exp_f32 v68, v68
  v_pk_mul_f32 v[192:193], v[192:193], v[208:209]
  v_rcp_f32 v66, v66
  v_pk_mul_f32 v[64:65], v[194:195], v[60:61] op_sel:[0,1] op_sel_hi:[1,1]
  v_rcp_f32 v67, v67
  v_cvt_pk_bf16_f32 v150, v140, v141
  v_exp_f32 v69, v69
  v_pk_mul_f32 v[142:143], v[142:143], v[66:67]
  v_pk_fma_f32 v[68:69], v[68:69], v[60:61], v[60:61] op_sel:[0,0,0] op_sel_hi:[1,0,0]
  v_exp_f32 v64, v64
  v_pk_mul_f32 v[194:195], v[194:195], v[210:211]
  v_rcp_f32 v68, v68
  v_pk_mul_f32 v[66:67], v[196:197], v[60:61] op_sel:[0,1] op_sel_hi:[1,1]
  v_rcp_f32 v69, v69
  v_cvt_pk_bf16_f32 v151, v142, v143
  buffer_store_dwordx4 v[148:151], v2, s[48:51], s75 offen offset:1024 sc1
  s_add_u32 s75, s75, 229376
  v_exp_f32 v65, v65
  v_pk_mul_f32 v[192:193], v[192:193], v[68:69]
  v_pk_fma_f32 v[64:65], v[64:65], v[60:61], v[60:61] op_sel:[0,0,0] op_sel_hi:[1,0,0]
  v_exp_f32 v66, v66
  v_pk_mul_f32 v[196:197], v[196:197], v[212:213]
  v_rcp_f32 v64, v64
  v_pk_mul_f32 v[68:69], v[198:199], v[60:61] op_sel:[0,1] op_sel_hi:[1,1]
  v_rcp_f32 v65, v65
  v_cvt_pk_bf16_f32 v208, v192, v193
  v_exp_f32 v67, v67
  v_pk_mul_f32 v[194:195], v[194:195], v[64:65]
  v_pk_fma_f32 v[66:67], v[66:67], v[60:61], v[60:61] op_sel:[0,0,0] op_sel_hi:[1,0,0]
  v_exp_f32 v68, v68
  v_pk_mul_f32 v[198:199], v[198:199], v[214:215]
  v_rcp_f32 v66, v66
  v_pk_mul_f32 v[64:65], v[200:201], v[60:61] op_sel:[0,1] op_sel_hi:[1,1]
  v_rcp_f32 v67, v67
  v_cvt_pk_bf16_f32 v209, v194, v195
  v_exp_f32 v69, v69
  v_pk_mul_f32 v[196:197], v[196:197], v[66:67]
  v_pk_fma_f32 v[68:69], v[68:69], v[60:61], v[60:61] op_sel:[0,0,0] op_sel_hi:[1,0,0]
  v_exp_f32 v64, v64
  v_pk_mul_f32 v[200:201], v[200:201], v[216:217]
  v_rcp_f32 v68, v68
  v_pk_mul_f32 v[66:67], v[202:203], v[60:61] op_sel:[0,1] op_sel_hi:[1,1]
  v_rcp_f32 v69, v69
  v_cvt_pk_bf16_f32 v210, v196, v197
  v_exp_f32 v65, v65
  v_pk_mul_f32 v[198:199], v[198:199], v[68:69]
  v_pk_fma_f32 v[64:65], v[64:65], v[60:61], v[60:61] op_sel:[0,0,0] op_sel_hi:[1,0,0]
  v_exp_f32 v66, v66
  v_pk_mul_f32 v[202:203], v[202:203], v[218:219]
  v_rcp_f32 v64, v64
  v_pk_mul_f32 v[68:69], v[204:205], v[60:61] op_sel:[0,1] op_sel_hi:[1,1]
  v_rcp_f32 v65, v65
  v_cvt_pk_bf16_f32 v211, v198, v199
  buffer_store_dwordx4 v[208:211], v2, s[48:51], s75 offen offset:0 sc1
  v_exp_f32 v67, v67
  v_pk_mul_f32 v[200:201], v[200:201], v[64:65]
  v_add_u32 v96, s71, v23
  v_pk_fma_f32 v[66:67], v[66:67], v[60:61], v[60:61] op_sel:[0,0,0] op_sel_hi:[1,0,0]
  v_exp_f32 v68, v68
  v_pk_mul_f32 v[204:205], v[204:205], v[220:221]
  v_rcp_f32 v66, v66
  v_pk_mul_f32 v[64:65], v[206:207], v[60:61] op_sel:[0,1] op_sel_hi:[1,1]
  v_rcp_f32 v67, v67
  v_cvt_pk_bf16_f32 v212, v200, v201
  v_exp_f32 v69, v69
  v_pk_mul_f32 v[202:203], v[202:203], v[66:67]
  s_waitcnt vmcnt(8)
  ds_write_b128 v96, v[72:75] offset:4240
  v_pk_fma_f32 v[68:69], v[68:69], v[60:61], v[60:61] op_sel:[0,0,0] op_sel_hi:[1,0,0]
  v_exp_f32 v64, v64
  v_pk_mul_f32 v[206:207], v[206:207], v[222:223]
  v_rcp_f32 v68, v68
  v_pk_mul_f32 v[66:67], v[160:161], v[58:59] op_sel:[0,1] op_sel_hi:[1,1]
  v_rcp_f32 v69, v69
  v_cvt_pk_bf16_f32 v213, v202, v203
  v_exp_f32 v65, v65
  v_pk_mul_f32 v[204:205], v[204:205], v[68:69]
  v_alignbit_b32 v88, v73, v72, 16
  v_pk_fma_f32 v[64:65], v[64:65], v[60:61], v[60:61] op_sel:[0,0,0] op_sel_hi:[1,0,0]
  v_exp_f32 v66, v66
  v_pk_mul_f32 v[160:161], v[160:161], v[176:177]
  v_rcp_f32 v64, v64
  v_pk_mul_f32 v[68:69], v[162:163], v[58:59] op_sel:[0,1] op_sel_hi:[1,1]
  v_rcp_f32 v65, v65
  v_cvt_pk_bf16_f32 v214, v204, v205
  v_exp_f32 v67, v67
  v_pk_mul_f32 v[206:207], v[206:207], v[64:65]
  v_alignbit_b32 v89, v74, v73, 16
  v_pk_fma_f32 v[66:67], v[66:67], v[58:59], v[58:59] op_sel:[0,0,0] op_sel_hi:[1,0,0]
  v_exp_f32 v68, v68
  v_pk_mul_f32 v[162:163], v[162:163], v[178:179]
  v_rcp_f32 v66, v66
  v_pk_mul_f32 v[64:65], v[164:165], v[58:59] op_sel:[0,1] op_sel_hi:[1,1]
  v_rcp_f32 v67, v67
  v_cvt_pk_bf16_f32 v215, v206, v207
  buffer_store_dwordx4 v[212:215], v2, s[48:51], s75 offen offset:1024 sc1
  s_add_u32 s75, s75, -114688
  v_exp_f32 v69, v69
  v_pk_mul_f32 v[160:161], v[160:161], v[66:67]
  v_alignbit_b32 v90, v75, v74, 16
  v_pk_fma_f32 v[68:69], v[68:69], v[58:59], v[58:59] op_sel:[0,0,0] op_sel_hi:[1,0,0]
  v_exp_f32 v64, v64
  v_pk_mul_f32 v[164:165], v[164:165], v[180:181]
  v_rcp_f32 v68, v68
  v_pk_mul_f32 v[66:67], v[166:167], v[58:59] op_sel:[0,1] op_sel_hi:[1,1]
  v_rcp_f32 v69, v69
  v_cvt_pk_bf16_f32 v176, v160, v161
  v_exp_f32 v65, v65
  v_pk_mul_f32 v[162:163], v[162:163], v[68:69]
  ds_write_b16 v96, v72 offset:14
  v_pk_fma_f32 v[64:65], v[64:65], v[58:59], v[58:59] op_sel:[0,0,0] op_sel_hi:[1,0,0]
  v_exp_f32 v66, v66
  v_pk_mul_f32 v[166:167], v[166:167], v[182:183]
  v_rcp_f32 v64, v64
  v_pk_mul_f32 v[68:69], v[168:169], v[58:59] op_sel:[0,1] op_sel_hi:[1,1]
  v_rcp_f32 v65, v65
  v_cvt_pk_bf16_f32 v177, v162, v163
  v_exp_f32 v67, v67
  v_pk_mul_f32 v[164:165], v[164:165], v[64:65]
  ds_write_b96 v96, v[88:90] offset:16
  v_pk_fma_f32 v[66:67], v[66:67], v[58:59], v[58:59] op_sel:[0,0,0] op_sel_hi:[1,0,0]
  v_exp_f32 v68, v68
  v_pk_mul_f32 v[168:169], v[168:169], v[184:185]
  v_rcp_f32 v66, v66
  v_pk_mul_f32 v[64:65], v[170:171], v[58:59] op_sel:[0,1] op_sel_hi:[1,1]
  v_rcp_f32 v67, v67
  v_cvt_pk_bf16_f32 v178, v164, v165
  v_exp_f32 v69, v69
  v_pk_mul_f32 v[166:167], v[166:167], v[66:67]
  ds_write_b16_d16_hi v96, v75 offset:28
  v_pk_fma_f32 v[68:69], v[68:69], v[58:59], v[58:59] op_sel:[0,0,0] op_sel_hi:[1,0,0]
  v_exp_f32 v64, v64
  v_pk_mul_f32 v[170:171], v[170:171], v[186:187]
  v_rcp_f32 v68, v68
  v_pk_mul_f32 v[66:67], v[172:173], v[58:59] op_sel:[0,1] op_sel_hi:[1,1]
  v_rcp_f32 v69, v69
  v_cvt_pk_bf16_f32 v179, v166, v167
  buffer_store_dwordx4 v[176:179], v2, s[48:51], s75 offen offset:0 sc1
  v_exp_f32 v65, v65
  v_pk_mul_f32 v[168:169], v[168:169], v[68:69]
  s_waitcnt vmcnt(9)
  ds_write_b128 v96, v[76:79] offset:5264
  v_pk_fma_f32 v[64:65], v[64:65], v[58:59], v[58:59] op_sel:[0,0,0] op_sel_hi:[1,0,0]
  v_exp_f32 v66, v66
  v_pk_mul_f32 v[172:173], v[172:173], v[188:189]
  v_rcp_f32 v64, v64
  v_pk_mul_f32 v[68:69], v[174:175], v[58:59] op_sel:[0,1] op_sel_hi:[1,1]
  v_rcp_f32 v65, v65
  v_cvt_pk_bf16_f32 v180, v168, v169
  v_exp_f32 v67, v67
  v_pk_mul_f32 v[170:171], v[170:171], v[64:65]
  v_alignbit_b32 v92, v77, v76, 16
  v_pk_fma_f32 v[66:67], v[66:67], v[58:59], v[58:59] op_sel:[0,0,0] op_sel_hi:[1,0,0]
  v_exp_f32 v68, v68
  v_pk_mul_f32 v[174:175], v[174:175], v[190:191]
  v_rcp_f32 v66, v66
  v_pk_mul_f32 v[64:65], v[224:225], v[62:63] op_sel:[0,1] op_sel_hi:[1,1]
  v_rcp_f32 v67, v67
  v_cvt_pk_bf16_f32 v181, v170, v171
  v_exp_f32 v69, v69
  v_pk_mul_f32 v[172:173], v[172:173], v[66:67]
  v_alignbit_b32 v93, v78, v77, 16
  v_pk_fma_f32 v[68:69], v[68:69], v[58:59], v[58:59] op_sel:[0,0,0] op_sel_hi:[1,0,0]
  v_exp_f32 v64, v64
  v_pk_mul_f32 v[224:225], v[224:225], v[240:241]
  v_rcp_f32 v68, v68
  v_pk_mul_f32 v[66:67], v[226:227], v[62:63] op_sel:[0,1] op_sel_hi:[1,1]
  v_rcp_f32 v69, v69
  v_cvt_pk_bf16_f32 v182, v172, v173
  v_exp_f32 v65, v65
  v_pk_mul_f32 v[174:175], v[174:175], v[68:69]
  v_alignbit_b32 v94, v79, v78, 16
  v_pk_fma_f32 v[64:65], v[64:65], v[62:63], v[62:63] op_sel:[0,0,0] op_sel_hi:[1,0,0]
  v_exp_f32 v66, v66
  v_pk_mul_f32 v[226:227], v[226:227], v[242:243]
  v_rcp_f32 v64, v64
  v_pk_mul_f32 v[68:69], v[228:229], v[62:63] op_sel:[0,1] op_sel_hi:[1,1]
  v_rcp_f32 v65, v65
  v_cvt_pk_bf16_f32 v183, v174, v175
  buffer_store_dwordx4 v[180:183], v2, s[48:51], s75 offen offset:1024 sc1
  s_add_u32 s75, s75, 229376
  v_exp_f32 v67, v67
  v_pk_mul_f32 v[224:225], v[224:225], v[64:65]
  ds_write_b16 v96, v76 offset:1038
  v_pk_fma_f32 v[66:67], v[66:67], v[62:63], v[62:63] op_sel:[0,0,0] op_sel_hi:[1,0,0]
  v_exp_f32 v68, v68
  v_pk_mul_f32 v[228:229], v[228:229], v[244:245]
  v_rcp_f32 v66, v66
  v_pk_mul_f32 v[64:65], v[230:231], v[62:63] op_sel:[0,1] op_sel_hi:[1,1]
  v_rcp_f32 v67, v67
  v_cvt_pk_bf16_f32 v240, v224, v225
  v_exp_f32 v69, v69
  v_pk_mul_f32 v[226:227], v[226:227], v[66:67]
  ds_write_b96 v96, v[92:94] offset:1040
  v_pk_fma_f32 v[68:69], v[68:69], v[62:63], v[62:63] op_sel:[0,0,0] op_sel_hi:[1,0,0]
  v_exp_f32 v64, v64
  v_pk_mul_f32 v[230:231], v[230:231], v[246:247]
  v_rcp_f32 v68, v68
  v_pk_mul_f32 v[66:67], v[232:233], v[62:63] op_sel:[0,1] op_sel_hi:[1,1]
  v_rcp_f32 v69, v69
  v_cvt_pk_bf16_f32 v241, v226, v227
  v_exp_f32 v65, v65
  v_pk_mul_f32 v[228:229], v[228:229], v[68:69]
  ds_write_b16_d16_hi v96, v79 offset:1052
  v_pk_fma_f32 v[64:65], v[64:65], v[62:63], v[62:63] op_sel:[0,0,0] op_sel_hi:[1,0,0]
  v_exp_f32 v66, v66
  v_pk_mul_f32 v[232:233], v[232:233], v[248:249]
  v_rcp_f32 v64, v64
  v_pk_mul_f32 v[68:69], v[234:235], v[62:63] op_sel:[0,1] op_sel_hi:[1,1]
  v_rcp_f32 v65, v65
  v_cvt_pk_bf16_f32 v242, v228, v229
  v_exp_f32 v67, v67
  v_pk_mul_f32 v[230:231], v[230:231], v[64:65]
  v_pk_fma_f32 v[66:67], v[66:67], v[62:63], v[62:63] op_sel:[0,0,0] op_sel_hi:[1,0,0]
  v_exp_f32 v68, v68
  v_pk_mul_f32 v[234:235], v[234:235], v[250:251]
  v_rcp_f32 v66, v66
  v_pk_mul_f32 v[64:65], v[236:237], v[62:63] op_sel:[0,1] op_sel_hi:[1,1]
  v_rcp_f32 v67, v67
  v_cvt_pk_bf16_f32 v243, v230, v231
  buffer_store_dwordx4 v[240:243], v2, s[48:51], s75 offen offset:0 sc1
  v_exp_f32 v69, v69
  v_pk_mul_f32 v[232:233], v[232:233], v[66:67]
  v_pk_fma_f32 v[68:69], v[68:69], v[62:63], v[62:63] op_sel:[0,0,0] op_sel_hi:[1,0,0]
  v_exp_f32 v64, v64
  v_pk_mul_f32 v[236:237], v[236:237], v[252:253]
  v_rcp_f32 v68, v68
  v_pk_mul_f32 v[66:67], v[238:239], v[62:63] op_sel:[0,1] op_sel_hi:[1,1]
  v_rcp_f32 v69, v69
  v_cvt_pk_bf16_f32 v244, v232, v233
  v_exp_f32 v65, v65
  v_pk_mul_f32 v[234:235], v[234:235], v[68:69]
  v_pk_fma_f32 v[64:65], v[64:65], v[62:63], v[62:63] op_sel:[0,0,0] op_sel_hi:[1,0,0]
  v_exp_f32 v66, v66
  v_pk_mul_f32 v[238:239], v[238:239], v[254:255]
  v_rcp_f32 v64, v64
  v_rcp_f32 v65, v65
  v_cvt_pk_bf16_f32 v245, v234, v235
  v_exp_f32 v67, v67
  v_pk_mul_f32 v[236:237], v[236:237], v[64:65]
  v_pk_fma_f32 v[66:67], v[66:67], v[62:63], v[62:63] op_sel:[0,0,0] op_sel_hi:[1,0,0]
  v_rcp_f32 v66, v66
  v_rcp_f32 v67, v67
  v_cvt_pk_bf16_f32 v246, v236, v237
  v_pk_mul_f32 v[238:239], v[238:239], v[66:67]
  v_cvt_pk_bf16_f32 v247, v238, v239
  buffer_store_dwordx4 v[244:247], v2, s[48:51], s75 offen offset:1024 sc1
  s_cmp_eq_u32 s70, s69
  s_cbranch_scc1 Lredo
  s_mov_b32 s58, 100000
Lsp9:
  s_sleep 1
  buffer_load_dword v0, off, s[48:51], s72 sc1
  s_waitcnt vmcnt(0)
  v_readfirstlane_b32 s57, v0
  s_nop 1
  s_cmp_ge_u32 s57, 32
  s_cbranch_scc1 Lok9
  s_sub_u32 s58, s58, 1
  s_cmp_lg_u32 s58, 0
  s_cbranch_scc1 Lsp9
Lok9:
  buffer_load_dwordx4 v[72:75], v23, s[48:51], s69 offen offset:0 sc1
  s_nop 0
  buffer_load_dwordx4 v[76:79], v23, s[48:51], s69 offen offset:1024 sc1
  s_waitcnt vmcnt(0)
  v_add_u32 v96, s71, v23
  ds_write_b128 v96, v[72:75] offset:4240
  v_alignbit_b32 v88, v73, v72, 16
  v_alignbit_b32 v89, v74, v73, 16
  v_alignbit_b32 v90, v75, v74, 16
  ds_write_b16 v96, v72 offset:14
  ds_write_b96 v96, v[88:90] offset:16
  ds_write_b16_d16_hi v96, v75 offset:28
  ds_write_b128 v96, v[76:79] offset:5264
  v_alignbit_b32 v92, v77, v76, 16
  v_alignbit_b32 v93, v78, v77, 16
  v_alignbit_b32 v94, v79, v78, 16
  ds_write_b16 v96, v76 offset:1038
  ds_write_b96 v96, v[92:94] offset:1040
  ds_write_b16_d16_hi v96, v79 offset:1052
Lredo:
  ds_write_b16 v46, v47
  s_waitcnt vmcnt(4) lgkmcnt(0)
  s_barrier
  ds_read_b128 v[64:67], v21 offset:3584
  ds_read_b128 v[96:99], v22 offset:0
  ds_read_b128 v[68:71], v21 offset:3072
  ds_read_b128 v[100:103], v22 offset:512
  ds_read_b128 v[72:75], v21 offset:2560
  ds_read_b128 v[104:107], v22 offset:1024
  s_cmp_lg_u32 s52, 0
  s_cbranch_scc1 Lsg3
  s_andn2_b32 s59, s73, 0x80
  s_mov_b64 exec, 3
  buffer_atomic_add v44, v43, s[48:51], s59 offen sc1
  s_mov_b64 exec, -1
Lsg3:
  s_add_u32 m0, s63, 66560
  s_nop 0
  buffer_load_dwordx4 v16, s[36:39], s67 offen lds
  buffer_load_dwordx4 v5, s[36:39], s67 offen offset:1024 lds
  buffer_load_dwordx4 v6, s[36:39], s67 offen offset:2048 lds
  buffer_load_dwordx4 v7, s[36:39], s67 offen offset:3072 lds
  s_add_u32 s67, s67, 28672
  s_add_u32 m0, s63, 82944
  s_waitcnt lgkmcnt(4)
  v_mfma_f32_16x16x32_bf16 v[192:195], v[64:67], v[96:99], 0
  ds_read_b128 v[76:79], v21 offset:2048
  s_waitcnt lgkmcnt(3)
  v_mfma_f32_16x16x32_bf16 v[196:199], v[68:71], v[96:99], 0
  ds_read_b128 v[108:111], v22 offset:1536
  v_mfma_f32_16x16x32_bf16 v[196:199], v[64:67], v[100:103], v[196:199]
  ds_read_b128 v[80:83], v21 offset:1536
  v_mfma_f32_16x16x32_bf16 v[200:203], v[68:71], v[100:103], 0
  ds_read_b128 v[112:115], v22 offset:2048
  s_waitcnt lgkmcnt(4)
  v_mfma_f32_16x16x32_bf16 v[200:203], v[72:75], v[96:99], v[200:203]
  ds_read_b128 v[84:87], v21 offset:1024
  buffer_load_dwordx4 v16, s[36:39], s67 offen lds
  v_mfma_f32_16x16x32_bf16 v[204:207], v[72:75], v[100:103], 0
  ds_read_b128 v[116:119], v22 offset:2560
  v_mfma_f32_16x16x32_bf16 v[200:203], v[64:67], v[104:107], v[200:203]
  ds_read_b128 v[88:91], v21 offset:512
  v_mfma_f32_16x16x32_bf16 v[204:207], v[68:71], v[104:107], v[204:207]
  ds_read_b128 v[120:123], v22 offset:3072
  buffer_load_dwordx4 v5, s[36:39], s67 offen offset:1024 lds
  v_mfma_f32_16x16x32_bf16 v[208:211], v[72:75], v[104:107], 0
  ds_read_b128 v[92:95], v21 offset:0
  s_waitcnt lgkmcnt(7)
  v_mfma_f32_16x16x32_bf16 v[204:207], v[76:79], v[96:99], v[204:207]
  ds_read_b128 v[124:127], v22 offset:3584
  v_mfma_f32_16x16x32_bf16 v[208:211], v[76:79], v[100:103], v[208:211]
  ds_read_b128 v[128:131], v21 offset:3648
  buffer_load_dwordx4 v6, s[36:39], s67 offen offset:2048 lds
  v_mfma_f32_16x16x32_bf16 v[212:215], v[76:79], v[104:107], 0
  ds_read_b128 v[160:163], v22 offset:64
  v_mfma_f32_16x16x32_bf16 v[204:207], v[64:67], v[108:111], v[204:207]
  ds_read_b64_tr_b16 a[32:33], v19 offset:1024
  v_mfma_f32_16x16x32_bf16 v[208:211], v[68:71], v[108:111], v[208:211]
  ds_read_b128 v[132:135], v21 offset:3136
  buffer_load_dwordx4 v7, s[36:39], s67 offen offset:3072 lds
  v_mfma_f32_16x16x32_bf16 v[212:215], v[72:75], v[108:111], v[212:215]
  ds_read_b128 v[164:167], v22 offset:576
  s_add_u32 s67, s67, 28672
  v_mfma_f32_16x16x32_bf16 v[216:219], v[76:79], v[108:111], 0
  ds_read_b64_tr_b16 a[34:35], v19 offset:2048
  ds_read_b64_tr_b16 a[36:37], v20 offset:1024
  s_waitcnt lgkmcnt(13)
  v_mfma_f32_16x16x32_bf16 v[208:211], v[80:83], v[96:99], v[208:211]
  ds_read_b128 v[136:139], v21 offset:2624
  v_mfma_f32_16x16x32_bf16 v[212:215], v[80:83], v[100:103], v[212:215]
  ds_read_b128 v[168:171], v22 offset:1088
  ds_read_b64_tr_b16 a[38:39], v20 offset:2048
  v_mfma_f32_16x16x32_bf16 v[216:219], v[80:83], v[104:107], v[216:219]
  ds_read_b64_tr_b16 a[40:41], v19 offset:3072
  ds_read_b64_tr_b16 a[42:43], v19 offset:4096
  v_mfma_f32_16x16x32_bf16 v[220:223], v[80:83], v[108:111], 0
  ds_read_b128 v[140:143], v21 offset:2112
  ds_read_b64_tr_b16 a[44:45], v20 offset:3072
  v_mfma_f32_16x16x32_bf16 v[208:211], v[64:67], v[112:115], v[208:211]
  ds_read_b128 v[172:175], v22 offset:1600
  ds_read_b64_tr_b16 a[46:47], v20 offset:4096
  v_mfma_f32_16x16x32_bf16 v[212:215], v[68:71], v[112:115], v[212:215]
  s_add_u32 m0, s63, 50176
  v_mfma_f32_16x16x32_bf16 v[216:219], v[72:75], v[112:115], v[216:219]
  ds_read_b128 v[144:147], v21 offset:1600
  v_mfma_f32_16x16x32_bf16 v[220:223], v[76:79], v[112:115], v[220:223]
  ds_read_b128 v[176:179], v22 offset:2112
  s_waitcnt lgkmcnt(15)
  v_mfma_f32_16x16x32_bf16 v[212:215], v[84:87], v[96:99], v[212:215]
  s_waitcnt lgkmcnt(2)
  buffer_load_dwordx4 v16, s[36:39], s67 offen lds
  v_mfma_f32_16x16x32_bf16 v[216:219], v[84:87], v[100:103], v[216:219]
  ds_read_b128 v[148:151], v21 offset:1088
  v_mfma_f32_16x16x32_bf16 v[220:223], v[84:87], v[104:107], v[220:223]
  ds_read_b128 v[180:183], v22 offset:2624
  v_mfma_f32_16x16x32_bf16 v[212:215], v[64:67], v[116:119], v[212:215]
  buffer_load_dwordx4 v5, s[36:39], s67 offen offset:1024 lds
  v_mfma_f32_16x16x32_bf16 v[216:219], v[68:71], v[116:119], v[216:219]
  ds_read_b128 v[152:155], v21 offset:576
  v_mfma_f32_16x16x32_bf16 v[220:223], v[72:75], v[116:119], v[220:223]
  ds_read_b128 v[184:187], v22 offset:3136
  v_mfma_f32_16x16x32_bf16 v[216:219], v[88:91], v[96:99], v[216:219]
  buffer_load_dwordx4 v6, s[36:39], s67 offen offset:2048 lds
  v_mfma_f32_16x16x32_bf16 v[220:223], v[88:91], v[100:103], v[220:223]
  ds_read_b128 v[156:159], v21 offset:64
  v_mfma_f32_16x16x32_bf16 v[216:219], v[64:67], v[120:123], v[216:219]
  ds_read_b128 v[188:191], v22 offset:3648
  v_mfma_f32_16x16x32_bf16 v[220:223], v[68:71], v[120:123], v[220:223]
  buffer_load_dwordx4 v7, s[36:39], s67 offen offset:3072 lds
  s_add_u32 s67, s67, 28672
  v_mfma_f32_16x16x32_bf16 v[220:223], v[92:95], v[96:99], v[220:223]
  v_mfma_f32_16x16x32_bf16 v[220:223], v[64:67], v[124:127], v[220:223]
  ds_read_b64_tr_b16 a[48:49], v17 offset:17408
  v_mfma_f32_16x16x32_bf16 v[192:195], v[128:131], v[160:163], v[192:195]
  ds_read_b64_tr_b16 a[50:51], v17 offset:18432
  v_mfma_f32_16x16x32_bf16 v[196:199], v[132:135], v[160:163], v[196:199]
  ds_read_b64_tr_b16 a[52:53], v18 offset:17408
  ds_read_b64_tr_b16 a[54:55], v18 offset:18432
  v_mfma_f32_16x16x32_bf16 v[196:199], v[128:131], v[164:167], v[196:199]
  ds_read_b128 v[64:67], v21 offset:3712
  ds_read_b64_tr_b16 a[56:57], v17 offset:19456
  v_mfma_f32_16x16x32_bf16 v[200:203], v[132:135], v[164:167], v[200:203]
  ds_read_b64_tr_b16 a[58:59], v17 offset:20480
  ds_read_b64_tr_b16 a[60:61], v18 offset:19456
  v_mfma_f32_16x16x32_bf16 v[200:203], v[136:139], v[160:163], v[200:203]
  ds_read_b128 v[96:99], v22 offset:128
  ds_read_b64_tr_b16 a[62:63], v18 offset:20480
  v_mfma_f32_16x16x32_bf16 v[204:207], v[136:139], v[164:167], v[204:207]
  s_add_u32 m0, s63, 17408
  v_mfma_f32_16x16x32_bf16 v[200:203], v[128:131], v[168:171], v[200:203]
  ds_read_b128 v[68:71], v21 offset:3200
  v_mfma_f32_16x16x32_bf16 v[204:207], v[132:135], v[168:171], v[204:207]
  s_waitcnt lgkmcnt(1)
  buffer_load_dwordx4 v16, s[36:39], s67 offen lds
  v_mfma_f32_16x16x32_bf16 v[208:211], v[136:139], v[168:171], v[208:211]
  ds_read_b128 v[100:103], v22 offset:640
  v_mfma_f32_16x16x32_bf16 v[204:207], v[140:143], v[160:163], v[204:207]
  ds_read_b64_tr_b16 a[64:65], v17 offset:33792
  v_mfma_f32_16x16x32_bf16 v[208:211], v[140:143], v[164:167], v[208:211]
  ds_read_b128 v[72:75], v21 offset:2688
  buffer_load_dwordx4 v5, s[36:39], s67 offen offset:1024 lds
  v_mfma_f32_16x16x32_bf16 v[212:215], v[140:143], v[168:171], v[212:215]
  ds_read_b64_tr_b16 a[66:67], v17 offset:34816
  ds_read_b64_tr_b16 a[68:69], v18 offset:33792
  v_mfma_f32_16x16x32_bf16 v[204:207], v[128:131], v[172:175], v[204:207]
  ds_read_b128 v[104:107], v22 offset:1152
  ds_read_b64_tr_b16 a[70:71], v18 offset:34816
  v_mfma_f32_16x16x32_bf16 v[208:211], v[132:135], v[172:175], v[208:211]
  buffer_load_dwordx4 v6, s[36:39], s67 offen offset:2048 lds
  ds_read_b64_tr_b16 a[72:73], v17 offset:35840
  v_mfma_f32_16x16x32_bf16 v[212:215], v[136:139], v[172:175], v[212:215]
  ds_read_b128 v[76:79], v21 offset:2176
  ds_read_b64_tr_b16 a[74:75], v17 offset:36864
  v_mfma_f32_16x16x32_bf16 v[216:219], v[140:143], v[172:175], v[216:219]
  ds_read_b64_tr_b16 a[76:77], v18 offset:35840
  ds_read_b64_tr_b16 a[78:79], v18 offset:36864
  v_mfma_f32_16x16x32_bf16 v[208:211], v[144:147], v[160:163], v[208:211]
  ds_read_b128 v[108:111], v22 offset:1664
  v_mfma_f32_16x16x32_bf16 v[212:215], v[144:147], v[164:167], v[212:215]
  buffer_load_dwordx4 v7, s[36:39], s67 offen offset:3072 lds
  s_add_u32 s67, s67, 28672
  v_mfma_f32_16x16x32_bf16 v[216:219], v[144:147], v[168:171], v[216:219]
  ds_read_b128 v[80:83], v21 offset:1664
  s_add_u32 m0, s63, 33792
  v_mfma_f32_16x16x32_bf16 v[220:223], v[144:147], v[172:175], v[220:223]
  ds_read_b64_tr_b16 a[80:81], v17 offset:1024
  v_mfma_f32_16x16x32_bf16 v[208:211], v[128:131], v[176:179], v[208:211]
  ds_read_b128 v[112:115], v22 offset:2176
  ds_read_b64_tr_b16 a[82:83], v17 offset:2048
  v_mfma_f32_16x16x32_bf16 v[212:215], v[132:135], v[176:179], v[212:215]
  s_waitcnt lgkmcnt(5)
  buffer_load_dwordx4 v16, s[36:39], s67 offen lds
  v_mfma_f32_16x16x32_bf16 v[216:219], v[136:139], v[176:179], v[216:219]
  ds_read_b128 v[84:87], v21 offset:1152
  ds_read_b64_tr_b16 a[84:85], v18 offset:1024
  v_mfma_f32_16x16x32_bf16 v[220:223], v[140:143], v[176:179], v[220:223]
  ds_read_b64_tr_b16 a[86:87], v18 offset:2048
  ds_read_b64_tr_b16 a[88:89], v17 offset:3072
  v_mfma_f32_16x16x32_bf16 v[212:215], v[148:151], v[160:163], v[212:215]
  ds_read_b128 v[116:119], v22 offset:2688
  s_waitcnt vmcnt(17)
  s_barrier
  s_cmp_lg_u32 s52, 0
  s_cbranch_scc1 Lsg4
  s_andn2_b32 s59, s73, 0x80
  s_add_u32 s59, s59, 4096
  s_mov_b64 exec, 3
  buffer_atomic_add v44, v43, s[48:51], s59 offen sc1
  s_mov_b64 exec, -1
Lsg4:
  v_mfma_f32_16x16x32_bf16 v[216:219], v[148:151], v[164:167], v[216:219]
  buffer_load_dwordx4 v5, s[36:39], s67 offen offset:1024 lds
  ds_read_b64_tr_b16 a[90:91], v17 offset:4096
  v_mfma_f32_16x16x32_bf16 v[220:223], v[148:151], v[168:171], v[220:223]
  ds_read_b128 v[88:91], v21 offset:640
  ds_read_b64_tr_b16 a[92:93], v18 offset:3072
  v_mfma_f32_16x16x32_bf16 v[212:215], v[128:131], v[180:183], v[212:215]
  ds_read_b64_tr_b16 a[94:95], v18 offset:4096
  v_mfma_f32_16x16x32_bf16 v[216:219], v[132:135], v[180:183], v[216:219]
  ds_read_b128 v[120:123], v22 offset:3200
  buffer_load_dwordx4 v6, s[36:39], s67 offen offset:2048 lds
  v_mfma_f32_16x16x32_bf16 v[220:223], v[136:139], v[180:183], v[220:223]
  v_mfma_f32_16x16x32_bf16 v[216:219], v[152:155], v[160:163], v[216:219]
  ds_read_b128 v[92:95], v21 offset:128
  v_mfma_f32_16x16x32_bf16 v[220:223], v[152:155], v[164:167], v[220:223]
  buffer_load_dwordx4 v7, s[36:39], s67 offen offset:3072 lds
  s_add_u32 s67, s67, 28672
  v_mfma_f32_16x16x32_bf16 v[216:219], v[128:131], v[184:187], v[216:219]
  ds_read_b128 v[124:127], v22 offset:3712
  s_add_u32 m0, s63, 1024
  v_mfma_f32_16x16x32_bf16 v[220:223], v[132:135], v[184:187], v[220:223]
  s_waitcnt vmcnt(16)
  ds_read_b64_tr_b16 a[96:97], v19 offset:17408
  v_mfma_f32_16x16x32_bf16 v[220:223], v[156:159], v[160:163], v[220:223]
  s_waitcnt lgkmcnt(4)
  buffer_load_dwordx4 v16, s[36:39], s67 offen lds
  v_mfma_f32_16x16x32_bf16 v[220:223], v[128:131], v[188:191], v[220:223]
  ds_read_b64_tr_b16 a[98:99], v19 offset:18432
  ds_read_b64_tr_b16 a[100:101], v20 offset:17408
  v_mfma_f32_16x16x32_bf16 v[192:195], v[64:67], v[96:99], v[192:195]
  ds_read_b64_tr_b16 a[102:103], v20 offset:18432
  v_mfma_f32_16x16x32_bf16 v[196:199], v[68:71], v[96:99], v[196:199]
  ds_read_b64_tr_b16 a[104:105], v19 offset:19456
  ds_read_b64_tr_b16 a[106:107], v19 offset:20480
  v_mfma_f32_16x16x32_bf16 v[196:199], v[64:67], v[100:103], v[196:199]
  ds_read_b128 v[128:131], v21 offset:3776
  buffer_load_dwordx4 v5, s[36:39], s67 offen offset:1024 lds
  v_mfma_f32_16x16x32_bf16 v[200:203], v[68:71], v[100:103], v[200:203]
  ds_read_b64_tr_b16 a[108:109], v20 offset:19456
  ds_read_b64_tr_b16 a[110:111], v20 offset:20480
  v_mfma_f32_16x16x32_bf16 v[200:203], v[72:75], v[96:99], v[200:203]
  ds_read_b128 v[160:163], v22 offset:192
  v_mfma_f32_16x16x32_bf16 v[204:207], v[72:75], v[100:103], v[204:207]
  buffer_load_dwordx4 v6, s[36:39], s67 offen offset:2048 lds
  v_mfma_f32_16x16x32_bf16 v[200:203], v[64:67], v[104:107], v[200:203]
  ds_read_b128 v[132:135], v21 offset:3264
  v_mfma_f32_16x16x32_bf16 v[204:207], v[68:71], v[104:107], v[204:207]
  v_mfma_f32_16x16x32_bf16 v[208:211], v[72:75], v[104:107], v[208:211]
  ds_read_b128 v[164:167], v22 offset:704
  buffer_load_dwordx4 v7, s[36:39], s67 offen offset:3072 lds
  v_mfma_f32_16x16x32_bf16 v[204:207], v[76:79], v[96:99], v[204:207]
  s_add_u32 s67, s67, 28672
  s_add_u32 m0, s63, 66560
  v_mfma_f32_16x16x32_bf16 v[208:211], v[76:79], v[100:103], v[208:211]
  ds_read_b128 v[136:139], v21 offset:2752
  v_mfma_f32_16x16x32_bf16 v[212:215], v[76:79], v[104:107], v[212:215]
  s_waitcnt vmcnt(16)
  ds_read_b64_tr_b16 a[112:113], v19 offset:33792
  v_mfma_f32_16x16x32_bf16 v[204:207], v[64:67], v[108:111], v[204:207]
  ds_read_b128 v[168:171], v22 offset:1216
  buffer_load_dword v0, off, s[48:51], s73 sc1
  v_mfma_f32_16x16x32_bf16 v[208:211], v[68:71], v[108:111], v[208:211]
  s_waitcnt lgkmcnt(6)
  buffer_load_dwordx4 v16, s[36:39], s67 offen lds
  v_mfma_f32_16x16x32_bf16 v[212:215], v[72:75], v[108:111], v[212:215]
  ds_read_b128 v[140:143], v21 offset:2240
  ds_read_b64_tr_b16 a[114:115], v19 offset:34816
  v_mfma_f32_16x16x32_bf16 v[216:219], v[76:79], v[108:111], v[216:219]
  ds_read_b64_tr_b16 a[116:117], v20 offset:33792
  ds_read_b64_tr_b16 a[118:119], v20 offset:34816
  v_mfma_f32_16x16x32_bf16 v[208:211], v[80:83], v[96:99], v[208:211]
  ds_read_b128 v[172:175], v22 offset:1728
  v_mfma_f32_16x16x32_bf16 v[212:215], v[80:83], v[100:103], v[212:215]
  buffer_load_dwordx4 v5, s[36:39], s67 offen offset:1024 lds
  ds_read_b64_tr_b16 a[120:121], v19 offset:35840
  v_mfma_f32_16x16x32_bf16 v[216:219], v[80:83], v[104:107], v[216:219]
  ds_read_b128 v[144:147], v21 offset:1728
  ds_read_b64_tr_b16 a[122:123], v19 offset:36864
  v_mfma_f32_16x16x32_bf16 v[220:223], v[80:83], v[108:111], v[220:223]
  ds_read_b64_tr_b16 a[124:125], v20 offset:35840
  ds_read_b64_tr_b16 a[126:127], v20 offset:36864
  v_mfma_f32_16x16x32_bf16 v[208:211], v[64:67], v[112:115], v[208:211]
  ds_read_b128 v[176:179], v22 offset:2240
  buffer_load_dwordx4 v6, s[36:39], s67 offen offset:2048 lds
  v_mfma_f32_16x16x32_bf16 v[212:215], v[68:71], v[112:115], v[212:215]
  v_mfma_f32_16x16x32_bf16 v[216:219], v[72:75], v[112:115], v[216:219]
  ds_read_b128 v[148:151], v21 offset:1216
  v_mfma_f32_16x16x32_bf16 v[220:223], v[76:79], v[112:115], v[220:223]
  buffer_load_dwordx4 v7, s[36:39], s67 offen offset:3072 lds
  s_add_u32 s67, s67, 28672
  v_mfma_f32_16x16x32_bf16 v[212:215], v[84:87], v[96:99], v[212:215]
  ds_read_b128 v[180:183], v22 offset:2752
  s_add_u32 m0, s63, 82944
  v_mfma_f32_16x16x32_bf16 v[216:219], v[84:87], v[100:103], v[216:219]
  v_mfma_f32_16x16x32_bf16 v[220:223], v[84:87], v[104:107], v[220:223]
  ds_read_b128 v[152:155], v21 offset:704
  v_mfma_f32_16x16x32_bf16 v[212:215], v[64:67], v[116:119], v[212:215]
  s_waitcnt lgkmcnt(4)
  buffer_load_dwordx4 v16, s[36:39], s67 offen lds
  v_mfma_f32_16x16x32_bf16 v[216:219], v[68:71], v[116:119], v[216:219]
  ds_read_b128 v[184:187], v22 offset:3264
  v_mfma_f32_16x16x32_bf16 v[220:223], v[72:75], v[116:119], v[220:223]
  s_waitcnt vmcnt(18)
  ds_read_b64_tr_b16 a[128:129], v19 offset:1024
  v_mfma_f32_16x16x32_bf16 v[216:219], v[88:91], v[96:99], v[216:219]
  ds_read_b128 v[156:159], v21 offset:192
  buffer_load_dwordx4 v5, s[36:39], s67 offen offset:1024 lds
  v_mfma_f32_16x16x32_bf16 v[220:223], v[88:91], v[100:103], v[220:223]
  ds_read_b64_tr_b16 a[130:131], v19 offset:2048
  ds_read_b64_tr_b16 a[132:133], v20 offset:1024
  v_mfma_f32_16x16x32_bf16 v[216:219], v[64:67], v[120:123], v[216:219]
  ds_read_b128 v[188:191], v22 offset:3776
  ds_read_b64_tr_b16 a[134:135], v20 offset:2048
  v_mfma_f32_16x16x32_bf16 v[220:223], v[68:71], v[120:123], v[220:223]
  buffer_load_dwordx4 v6, s[36:39], s67 offen offset:2048 lds
  ds_read_b64_tr_b16 a[136:137], v19 offset:3072
  v_mfma_f32_16x16x32_bf16 v[220:223], v[92:95], v[96:99], v[220:223]
  ds_read_b64_tr_b16 a[138:139], v19 offset:4096
  ds_read_b64_tr_b16 a[140:141], v20 offset:3072
  v_mfma_f32_16x16x32_bf16 v[220:223], v[64:67], v[124:127], v[220:223]
  ds_read_b64_tr_b16 a[142:143], v20 offset:4096
  v_mfma_f32_16x16x32_bf16 v[192:195], v[128:131], v[160:163], v[192:195]
  s_waitcnt vmcnt(7)
  v_readfirstlane_b32 s57, v0
  s_nop 1
  s_cmp_ge_u32 s57, 14
  s_cbranch_scc1 Lok5
  s_mov_b32 s58, 100000
Lsp5:
  s_sleep 1
  buffer_load_dword v0, off, s[48:51], s73 sc1
  s_waitcnt vmcnt(0)
  v_readfirstlane_b32 s57, v0
  s_nop 1
  s_cmp_ge_u32 s57, 14
  s_cbranch_scc1 Lok5
  s_sub_u32 s58, s58, 1
  s_cmp_lg_u32 s58, 0
  s_cbranch_scc1 Lsp5
Lok5:
  v_mfma_f32_16x16x32_bf16 v[196:199], v[132:135], v[160:163], v[196:199]
  buffer_load_dwordx4 v7, s[36:39], s67 offen offset:3072 lds
  s_add_u32 s67, s67, 28672
  v_mfma_f32_16x16x32_bf16 v[196:199], v[128:131], v[164:167], v[196:199]
  v_mfma_f32_16x16x32_bf16 v[200:203], v[132:135], v[164:167], v[200:203]
  v_mfma_f32_16x16x32_bf16 v[200:203], v[136:139], v[160:163], v[200:203]
  buffer_load_dwordx4 v[64:67], v2, s[48:51], s77 offen offset:0 sc1
  v_mfma_f32_16x16x32_bf16 v[204:207], v[136:139], v[164:167], v[204:207]
  v_mfma_f32_16x16x32_bf16 v[200:203], v[128:131], v[168:171], v[200:203]
  buffer_load_dwordx4 v[68:71], v2, s[48:51], s77 offen offset:1024 sc1
  v_mfma_f32_16x16x32_bf16 v[204:207], v[132:135], v[168:171], v[204:207]
  v_mfma_f32_16x16x32_bf16 v[208:211], v[136:139], v[168:171], v[208:211]
  v_mfma_f32_16x16x32_bf16 v[204:207], v[140:143], v[160:163], v[204:207]
  buffer_load_dwordx4 v[72:75], v2, s[48:51], s77 offen offset:2048 sc1
  v_mfma_f32_16x16x32_bf16 v[208:211], v[140:143], v[164:167], v[208:211]
  v_mfma_f32_16x16x32_bf16 v[212:215], v[140:143], v[168:171], v[212:215]
  v_mfma_f32_16x16x32_bf16 v[204:207], v[128:131], v[172:175], v[204:207]
  buffer_load_dwordx4 v[76:79], v2, s[48:51], s77 offen offset:3072 sc1
  s_add_u32 s77, s77, 4096
  v_mfma_f32_16x16x32_bf16 v[208:211], v[132:135], v[172:175], v[208:211]
  ds_read_b64_tr_b16 a[144:145], v17 offset:17408
  v_mfma_f32_16x16x32_bf16 v[212:215], v[136:139], v[172:175], v[212:215]
  buffer_load_dwordx4 v[80:83], v2, s[48:51], s77 offen offset:0 sc1
  ds_read_b64_tr_b16 a[146:147], v17 offset:18432
  v_mfma_f32_16x16x32_bf16 v[216:219], v[140:143], v[172:175], v[216:219]
  ds_read_b64_tr_b16 a[148:149], v18 offset:17408
  ds_read_b64_tr_b16 a[150:151], v18 offset:18432
  s_waitcnt lgkmcnt(9)
  v_mfma_f32_16x16x32_bf16 v[208:211], v[144:147], v[160:163], v[208:211]
  ds_read_b64_tr_b16 a[152:153], v17 offset:19456
  v_mfma_f32_16x16x32_bf16 v[212:215], v[144:147], v[164:167], v[212:215]
  buffer_load_dwordx4 v[84:87], v2, s[48:51], s77 offen offset:1024 sc1
  ds_read_b64_tr_b16 a[154:155], v17 offset:20480
  v_mfma_f32_16x16x32_bf16 v[216:219], v[144:147], v[168:171], v[216:219]
  s_barrier
  v_mfma_f32_16x16x32_bf16 v[220:223], v[144:147], v[172:175], v[220:223]
  ds_read_b64_tr_b16 a[156:157], v18 offset:19456
  ds_read_b64_tr_b16 a[158:159], v18 offset:20480
  v_mfma_f32_16x16x32_bf16 v[208:211], v[128:131], v[176:179], v[208:211]
  buffer_load_dwordx4 v[88:91], v2, s[48:51], s77 offen offset:2048 sc1
  v_add_u32 v3, s0, v2
  v_mfma_f32_16x16x32_bf16 v[212:215], v[132:135], v[176:179], v[212:215]
  v_accvgpr_read_b32 v8, a231
  s_add_u32 s1, s76, 229376
  v_mfma_f32_16x16x32_bf16 v[216:219], v[136:139], v[176:179], v[216:219]
  buffer_load_dwordx4 v[92:95], v2, s[48:51], s77 offen offset:3072 sc1
  s_add_u32 s77, s77, 4096
  v_mfma_f32_16x16x32_bf16 v[220:223], v[140:143], v[176:179], v[220:223]
  s_mul_i32 s59, s52, 6144
  v_add_u32 v14, s59, v3
  v_mfma_f32_16x16x32_bf16 v[212:215], v[148:151], v[160:163], v[212:215]
  v_mfma_f32_16x16x32_bf16 v[216:219], v[148:151], v[164:167], v[216:219]
  buffer_load_dwordx4 v[96:99], v2, s[48:51], s77 offen offset:0 sc1
  v_mfma_f32_16x16x32_bf16 v[220:223], v[148:151], v[168:171], v[220:223]
  v_mfma_f32_16x16x32_bf16 v[212:215], v[128:131], v[180:183], v[212:215]
  ds_read_b64_tr_b16 a[160:161], v17 offset:33792
  v_mfma_f32_16x16x32_bf16 v[216:219], v[132:135], v[180:183], v[216:219]
  buffer_load_dwordx4 v[100:103], v2, s[48:51], s77 offen offset:1024 sc1
  ds_read_b64_tr_b16 a[162:163], v17 offset:34816
  v_mfma_f32_16x16x32_bf16 v[220:223], v[136:139], v[180:183], v[220:223]
  ds_read_b64_tr_b16 a[164:165], v18 offset:33792
  ds_read_b64_tr_b16 a[166:167], v18 offset:34816
  v_mfma_f32_16x16x32_bf16 v[216:219], v[152:155], v[160:163], v[216:219]
  buffer_load_dwordx4 v[104:107], v2, s[48:51], s77 offen offset:2048 sc1
  ds_read_b64_tr_b16 a[168:169], v17 offset:35840
  v_mfma_f32_16x16x32_bf16 v[220:223], v[152:155], v[164:167], v[220:223]
  ds_read_b64_tr_b16 a[170:171], v17 offset:36864
  ds_read_b64_tr_b16 a[172:173], v18 offset:35840
  v_mfma_f32_16x16x32_bf16 v[216:219], v[128:131], v[184:187], v[216:219]
  ds_read_b64_tr_b16 a[174:175], v18 offset:36864
  v_mfma_f32_16x16x32_bf16 v[220:223], v[132:135], v[184:187], v[220:223]
  buffer_load_dwordx4 v[108:111], v2, s[48:51], s77 offen offset:3072 sc1
  s_add_u32 s77, s77, 4096
  v_mfma_f32_16x16x32_bf16 v[220:223], v[156:159], v[160:163], v[220:223]
  v_mfma_f32_16x16x32_bf16 v[220:223], v[128:131], v[188:191], v[220:223]
  ds_write_b128 v14, v[204:207] offset:3072
  ds_write_b128 v14, v[200:203] offset:2048
  s_waitcnt vmcnt(11)
  v_mfma_f32_32x32x16_bf16 v[224:239], a[0:3], v[64:67], 0
  ds_write_b128 v14, v[196:199] offset:1024
  v_mfma_f32_32x32x16_bf16 v[240:255], a[4:7], v[64:67], 0
  buffer_load_dwordx4 v[112:115], v2, s[48:51], s77 offen offset:0 sc1
  ds_write_b128 v14, v[192:195] offset:0
  s_waitcnt vmcnt(11)
  v_mfma_f32_32x32x16_bf16 v[224:239], a[8:11], v[68:71], v[224:239]
  ds_write_b128 v14, v[208:211] offset:4096
  v_mfma_f32_32x32x16_bf16 v[240:255], a[12:15], v[68:71], v[240:255]
  buffer_load_dwordx4 v[116:119], v2, s[48:51], s77 offen offset:1024 sc1
  ds_write_b128 v14, v[212:215] offset:5120
  s_waitcnt vmcnt(11)
  v_mfma_f32_32x32x16_bf16 v[224:239], a[16:19], v[72:75], v[224:239]
  s_add_u32 s73, s73, 4096
  buffer_load_dword v0, off, s[48:51], s73 sc1
  ds_read_b64_tr_b16 a[176:177], v17 offset:1024
  ds_read_b64_tr_b16 a[178:179], v17 offset:2048
  v_mfma_f32_32x32x16_bf16 v[240:255], a[20:23], v[72:75], v[240:255]
  buffer_load_dwordx4 v[120:123], v2, s[48:51], s77 offen offset:2048 sc1
  ds_write_b128 v14, v[216:219] offset:6144
  ds_read_b64_tr_b16 a[180:181], v18 offset:1024
  s_waitcnt vmcnt(12)
  v_mfma_f32_32x32x16_bf16 v[224:239], a[24:27], v[76:79], v[224:239]
  ds_write_b128 v14, v[220:223] offset:7168
  ds_read_b64_tr_b16 a[182:183], v18 offset:2048
  v_mfma_f32_32x32x16_bf16 v[240:255], a[28:31], v[76:79], v[240:255]
  buffer_load_dwordx4 v[124:127], v2, s[48:51], s77 offen offset:3072 sc1
  s_add_u32 s77, s77, 4096
  ds_read_b64_tr_b16 a[184:185], v17 offset:3072
  ds_read_b64_tr_b16 a[186:187], v17 offset:4096
  ds_read_b64_tr_b16 a[188:189], v18 offset:3072
  ds_read_b64_tr_b16 a[190:191], v18 offset:4096
  s_waitcnt vmcnt(12)
  v_mfma_f32_32x32x16_bf16 v[224:239], a[32:35], v[80:83], v[224:239]
  s_waitcnt lgkmcnt(5)
  s_barrier
  ds_read_b128 v[128:131], v3 offset:0
  ds_read_b128 v[132:135], v3 offset:8192
  v_mfma_f32_32x32x16_bf16 v[240:255], a[36:39], v[80:83], v[240:255]
  buffer_load_dwordx4 v[64:67], v2, s[48:51], s77 offen offset:0 sc1
  ds_read_b128 v[136:139], v3 offset:16384
  ds_read_b128 v[140:143], v3 offset:24576
  ds_read_b128 v[144:147], v3 offset:1024
  ds_read_b64_tr_b16 a[192:193], v19 offset:17408
  s_waitcnt vmcnt(12)
  v_mfma_f32_32x32x16_bf16 v[224:239], a[40:43], v[84:87], v[224:239]
  ds_read_b128 v[148:151], v3 offset:9216
  ds_read_b128 v[152:155], v3 offset:17408
  ds_read_b128 v[156:159], v3 offset:25600
  ds_read_b64_tr_b16 a[194:195], v19 offset:18432
  ds_read_b64_tr_b16 a[196:197], v20 offset:17408
  v_mfma_f32_32x32x16_bf16 v[240:255], a[44:47], v[84:87], v[240:255]
  buffer_load_dwordx4 v[68:71], v2, s[48:51], s77 offen offset:1024 sc1
  ds_read_b64_tr_b16 a[198:199], v20 offset:18432
  ds_read_b64_tr_b16 a[200:201], v19 offset:19456
  ds_read_b64_tr_b16 a[202:203], v19 offset:20480
  ds_read_b64_tr_b16 a[204:205], v20 offset:19456
  ds_read_b64_tr_b16 a[206:207], v20 offset:20480
  s_waitcnt vmcnt(12)
  v_mfma_f32_32x32x16_bf16 v[224:239], a[48:51], v[88:91], v[224:239]
  s_waitcnt lgkmcnt(12)
  v_add_f32 v128, v128, v132
  v_add_f32 v136, v136, v140
  v_cvt_pk_bf16_f32 v160, v128, v136
  v_add_f32 v129, v129, v133
  v_mfma_f32_32x32x16_bf16 v[240:255], a[52:55], v[88:91], v[240:255]
  buffer_load_dwordx4 v[72:75], v2, s[48:51], s77 offen offset:2048 sc1
  v_add_f32 v137, v137, v141
  v_cvt_pk_bf16_f32 v161, v129, v137
  v_add_f32 v130, v130, v134
  v_add_f32 v138, v138, v142
  v_cvt_pk_bf16_f32 v162, v130, v138
  s_waitcnt vmcnt(12)
  v_mfma_f32_32x32x16_bf16 v[224:239], a[56:59], v[92:95], v[224:239]
  v_add_f32 v131, v131, v135
  v_add_f32 v139, v139, v143
  v_cvt_pk_bf16_f32 v163, v131, v139
  v_mfma_f32_32x32x16_bf16 v[240:255], a[60:63], v[92:95], v[240:255]
  buffer_load_dwordx4 v[76:79], v2, s[48:51], s77 offen offset:3072 sc1
  s_add_u32 s77, s77, 4096
  buffer_store_dwordx4 v[160:163], v8, s[48:51], s76 offen sc1
  s_waitcnt vmcnt(13)
  v_mfma_f32_32x32x16_bf16 v[224:239], a[64:67], v[96:99], v[224:239]
  s_waitcnt lgkmcnt(7)
  v_add_f32 v144, v144, v148
  v_add_f32 v152, v152, v156
  v_cvt_pk_bf16_f32 v164, v144, v152
  v_add_f32 v145, v145, v149
  v_mfma_f32_32x32x16_bf16 v[240:255], a[68:71], v[96:99], v[240:255]
  buffer_load_dwordx4 v[80:83], v2, s[48:51], s77 offen offset:0 sc1
  v_add_f32 v153, v153, v157
  v_cvt_pk_bf16_f32 v165, v145, v153
  v_add_f32 v146, v146, v150
  v_add_f32 v154, v154, v158
  v_cvt_pk_bf16_f32 v166, v146, v154
  s_waitcnt vmcnt(13)
  v_mfma_f32_32x32x16_bf16 v[224:239], a[72:75], v[100:103], v[224:239]
  v_add_f32 v147, v147, v151
  v_add_f32 v155, v155, v159
  v_cvt_pk_bf16_f32 v167, v147, v155
  ds_read_b64_tr_b16 a[208:209], v19 offset:33792
  v_mfma_f32_32x32x16_bf16 v[240:255], a[76:79], v[100:103], v[240:255]
  buffer_load_dwordx4 v[84:87], v2, s[48:51], s77 offen offset:1024 sc1
  buffer_store_dwordx4 v[164:167], v8, s[48:51], s1 offen sc1
  ds_read_b64_tr_b16 a[210:211], v19 offset:34816
  s_waitcnt vmcnt(14)
  v_mfma_f32_32x32x16_bf16 v[224:239], a[80:83], v[104:107], v[224:239]
  ds_read_b64_tr_b16 a[212:213], v20 offset:33792
  ds_read_b64_tr_b16 a[214:215], v20 offset:34816
  ds_read_b64_tr_b16 a[216:217], v19 offset:35840
  ds_read_b64_tr_b16 a[218:219], v19 offset:36864
  ds_read_b64_tr_b16 a[220:221], v20 offset:35840
  v_mfma_f32_32x32x16_bf16 v[240:255], a[84:87], v[104:107], v[240:255]
  buffer_load_dwordx4 v[88:91], v2, s[48:51], s77 offen offset:2048 sc1
  ds_read_b64_tr_b16 a[222:223], v20 offset:36864
  v_accvgpr_read_b32 v3, a224
  v_accvgpr_read_b32 v14, a225
  v_accvgpr_read_b32 v5, a226
  s_movk_i32 s1, 28672
  s_waitcnt vmcnt(14)
  v_mfma_f32_32x32x16_bf16 v[224:239], a[88:91], v[108:111], v[224:239]
  buffer_load_dwordx2 v[36:37], v14, s[48:51], s79 offen sc1
  buffer_load_dwordx2 v[38:39], v14, s[48:51], s79 offen offset:256 sc1
  buffer_load_dwordx4 v[28:31], v3, s[4:7], 0 offen
  buffer_load_dwordx4 v[32:35], v3, s[4:7], s1 offen
  v_mov_b32 v168, 0
  v_mfma_f32_32x32x16_bf16 v[240:255], a[92:95], v[108:111], v[240:255]
  buffer_load_dwordx4 v[92:95], v2, s[48:51], s77 offen offset:3072 sc1
  s_add_u32 s77, s77, 4096
  ds_read_u16_d16_hi v168, v5 offset:64
  v_mov_b32 v169, 0
  ds_read_u16_d16_hi v169, v5 offset:192
  v_mov_b32 v170, 0
  s_waitcnt vmcnt(18)
  v_mfma_f32_32x32x16_bf16 v[224:239], a[96:99], v[112:115], v[224:239]
  ds_read_u16_d16_hi v170, v5 offset:320
  v_mov_b32 v171, 0
  ds_read_u16_d16_hi v171, v5 offset:448
  v_mov_b32 v172, 0
  ds_read_u16_d16_hi v172, v5 offset:576
  v_mfma_f32_32x32x16_bf16 v[240:255], a[100:103], v[112:115], v[240:255]
  buffer_load_dwordx4 v[96:99], v2, s[48:51], s77 offen offset:0 sc1
  v_mov_b32 v173, 0
  ds_read_u16_d16_hi v173, v5 offset:704
  v_mov_b32 v174, 0
  ds_read_u16_d16_hi v174, v5 offset:832
  v_mov_b32 v175, 0
  s_waitcnt vmcnt(18)
  v_mfma_f32_32x32x16_bf16 v[224:239], a[104:107], v[116:119], v[224:239]
  ds_read_u16_d16_hi v175, v5 offset:960
  v_mov_b32 v176, 0
  ds_read_u16_d16_hi v176, v5 offset:0
  v_mov_b32 v177, 0
  ds_read_u16_d16_hi v177, v5 offset:128
  v_mfma_f32_32x32x16_bf16 v[240:255], a[108:111], v[116:119], v[240:255]
  buffer_load_dwordx4 v[100:103], v2, s[48:51], s77 offen offset:1024 sc1
  v_mov_b32 v178, 0
  ds_read_u16_d16_hi v178, v5 offset:256
  v_mov_b32 v179, 0
  ds_read_u16_d16_hi v179, v5 offset:384
  v_mov_b32 v180, 0
  s_waitcnt vmcnt(17)
  v_mfma_f32_32x32x16_bf16 v[224:239], a[112:115], v[120:123], v[224:239]
  ds_read_u16_d16_hi v180, v5 offset:512
  v_mov_b32 v181, 0
  ds_read_u16_d16_hi v181, v5 offset:640
  v_mov_b32 v182, 0
  ds_read_u16_d16_hi v182, v5 offset:768
  v_mfma_f32_32x32x16_bf16 v[240:255], a[116:119], v[120:123], v[240:255]
  buffer_load_dwordx4 v[104:107], v2, s[48:51], s77 offen offset:2048 sc1
  v_mov_b32 v183, 0
  ds_read_u16_d16_hi v183, v5 offset:896
  v_accvgpr_read_b32 v8, a227
  v_accvgpr_read_b32 v10, a228
  v_accvgpr_read_b32 v6, a229
  s_waitcnt vmcnt(17)
  v_mfma_f32_32x32x16_bf16 v[224:239], a[120:123], v[124:127], v[224:239]
  v_accvgpr_read_b32 v7, a230
  v_xor_b32 v9, 16, v8
  v_xor_b32 v11, 32, v10
  v_xor_b32 v12, 64, v10
  v_xor_b32 v13, 0x60, v10
  v_mfma_f32_32x32x16_bf16 v[240:255], a[124:127], v[124:127], v[240:255]
  buffer_load_dwordx4 v[108:111], v2, s[48:51], s77 offen offset:3072 sc1
  s_add_u32 s77, s77, 90112
  s_waitcnt lgkmcnt(0)
  v_lshlrev_b32 v14, 16, v24
  v_mul_f32 v168, v168, v14
  v_mul_f32 v176, v176, v14
  s_waitcnt vmcnt(17)
  v_mfma_f32_32x32x16_bf16 v[224:239], a[128:131], v[64:67], v[224:239]
  v_readfirstlane_b32 s57, v0
  s_nop 1
  s_cmp_ge_u32 s57, 14
  s_cbranch_scc1 Lok6
  s_mov_b32 s58, 100000
Lsp6:
  s_sleep 1
  buffer_load_dword v0, off, s[48:51], s73 sc1
  s_waitcnt vmcnt(0)
  v_readfirstlane_b32 s57, v0
  s_nop 1
  s_cmp_ge_u32 s57, 14
  s_cbranch_scc1 Lok6
  s_sub_u32 s58, s58, 1
  s_cmp_lg_u32 s58, 0
  s_cbranch_scc1 Lsp6
Lok6:
  v_and_b32 v14, s64, v24
  v_mfma_f32_32x32x16_bf16 v[240:255], a[132:135], v[64:67], v[240:255]
  buffer_load_dwordx4 v[112:115], v2, s[48:51], s77 offen offset:0 sc1
  v_mul_f32 v169, v169, v14
  v_mul_f32 v177, v177, v14
  v_lshlrev_b32 v14, 16, v25
  v_mul_f32 v170, v170, v14
  v_mul_f32 v178, v178, v14
  s_waitcnt vmcnt(17)
  v_mfma_f32_32x32x16_bf16 v[224:239], a[136:139], v[68:71], v[224:239]
  v_and_b32 v14, s64, v25
  v_mul_f32 v171, v171, v14
  v_mul_f32 v179, v179, v14
  v_lshlrev_b32 v14, 16, v26
  v_mul_f32 v172, v172, v14
  v_mfma_f32_32x32x16_bf16 v[240:255], a[140:143], v[68:71], v[240:255]
  buffer_load_dwordx4 v[116:119], v2, s[48:51], s77 offen offset:1024 sc1
  v_mul_f32 v180, v180, v14
  v_and_b32 v14, s64, v26
  v_mul_f32 v173, v173, v14
  v_mul_f32 v181, v181, v14
  v_lshlrev_b32 v14, 16, v27
  s_waitcnt vmcnt(17)
  v_mfma_f32_32x32x16_bf16 v[224:239], a[144:147], v[72:75], v[224:239]
  v_mul_f32 v174, v174, v14
  v_mul_f32 v182, v182, v14
  v_and_b32 v14, s64, v27
  v_mul_f32 v175, v175, v14
  v_mul_f32 v183, v183, v14
  v_mfma_f32_32x32x16_bf16 v[240:255], a[148:151], v[72:75], v[240:255]
  buffer_load_dwordx4 v[120:123], v2, s[48:51], s77 offen offset:2048 sc1
  s_waitcnt vmcnt(13)
  s_barrier
  s_cmp_lg_u32 s52, 0
  s_cbranch_scc1 Lsg10
  s_andn2_b32 s59, s74, 0x380
  s_mov_b64 exec, 255
  buffer_atomic_add v44, v43, s[48:51], s59 offen sc1
  s_mov_b64 exec, -1
Lsg10:
  v_mfma_f32_32x32x16_bf16 v[224:239], a[152:155], v[76:79], v[224:239]
  s_mov_b32 s3, 0xbfb8aa3b
  v_add_u32 v5, 1024, v7
  v_mfma_f32_32x32x16_bf16 v[240:255], a[156:159], v[76:79], v[240:255]
  buffer_load_dwordx4 v[124:127], v2, s[48:51], s77 offen offset:3072 sc1
  s_add_u32 s77, s77, 4096
  v_mfma_f32_32x32x16_bf16 v[224:239], a[160:163], v[80:83], v[224:239]
  v_mfma_f32_32x32x16_bf16 v[240:255], a[164:167], v[80:83], v[240:255]
  buffer_load_dwordx4 v[64:67], v2, s[48:51], s77 offen offset:0 sc1
  v_mfma_f32_32x32x16_bf16 v[224:239], a[168:171], v[84:87], v[224:239]
  v_mfma_f32_32x32x16_bf16 v[240:255], a[172:175], v[84:87], v[240:255]
  buffer_load_dwordx4 v[68:71], v2, s[48:51], s77 offen offset:1024 sc1
  s_waitcnt vmcnt(15)
  v_mfma_f32_32x32x16_bf16 v[224:239], a[176:179], v[88:91], v[224:239]
  v_mfma_f32_32x32x16_bf16 v[240:255], a[180:183], v[88:91], v[240:255]
  buffer_load_dwordx4 v[72:75], v2, s[48:51], s77 offen offset:2048 sc1
  s_waitcnt vmcnt(11)
  v_mfma_f32_32x32x16_bf16 v[224:239], a[184:187], v[92:95], v[224:239]
  v_mfma_f32_32x32x16_bf16 v[240:255], a[188:191], v[92:95], v[240:255]
  buffer_load_dwordx4 v[76:79], v2, s[48:51], s77 offen offset:3072 sc1
  s_add_u32 s77, s77, 4096
  v_rcp_f32 v37, v37
  v_and_b32 v36, s64, v36
  s_waitcnt vmcnt(11)
  v_mfma_f32_32x32x16_bf16 v[224:239], a[192:195], v[96:99], v[224:239]
  v_rcp_f32 v39, v39
  v_and_b32 v38, s64, v38
  v_lshlrev_b32 v16, 16, v28
  v_add_f32 v48, v16, v36
  v_mfma_f32_32x32x16_bf16 v[240:255], a[196:199], v[96:99], v[240:255]
  buffer_load_dwordx4 v[80:83], v2, s[48:51], s77 offen offset:0 sc1
  v_mul_f32 v48, v48, v37
  v_and_b32 v17, s64, v28
  v_add_f32 v49, v17, v36
  v_mul_f32 v49, v49, v37
  v_lshlrev_b32 v18, 16, v29
  s_waitcnt vmcnt(11)
  v_mfma_f32_32x32x16_bf16 v[224:239], a[200:203], v[100:103], v[224:239]
  v_add_f32 v50, v18, v36
  v_mul_f32 v50, v50, v37
  v_and_b32 v19, s64, v29
  v_add_f32 v51, v19, v36
  v_mul_f32 v51, v51, v37
  v_mfma_f32_32x32x16_bf16 v[240:255], a[204:207], v[100:103], v[240:255]
  buffer_load_dwordx4 v[84:87], v2, s[48:51], s77 offen offset:1024 sc1
  v_lshlrev_b32 v20, 16, v30
  v_add_f32 v52, v20, v36
  v_mul_f32 v52, v52, v37
  v_and_b32 v21, s64, v30
  v_add_f32 v53, v21, v36
  s_waitcnt vmcnt(11)
  v_mfma_f32_32x32x16_bf16 v[224:239], a[208:211], v[104:107], v[224:239]
  v_mul_f32 v53, v53, v37
  v_lshlrev_b32 v22, 16, v31
  v_add_f32 v54, v22, v36
  v_mul_f32 v54, v54, v37
  v_and_b32 v23, s64, v31
  v_mfma_f32_32x32x16_bf16 v[240:255], a[212:215], v[104:107], v[240:255]
  buffer_load_dwordx4 v[88:91], v2, s[48:51], s77 offen offset:2048 sc1
  v_add_f32 v55, v23, v36
  v_mul_f32 v55, v55, v37
  v_lshlrev_b32 v184, 16, v32
  v_add_f32 v56, v184, v38
  v_mul_f32 v56, v56, v39
  s_waitcnt vmcnt(11)
  v_mfma_f32_32x32x16_bf16 v[224:239], a[216:219], v[108:111], v[224:239]
  v_and_b32 v185, s64, v32
  v_add_f32 v57, v185, v38
  v_mul_f32 v57, v57, v39
  v_lshlrev_b32 v186, 16, v33
  v_add_f32 v58, v186, v38
  v_mfma_f32_32x32x16_bf16 v[240:255], a[220:223], v[108:111], v[240:255]
  buffer_load_dwordx4 v[92:95], v2, s[48:51], s77 offen offset:3072 sc1
  s_add_u32 s77, s77, 4096
  v_mul_f32 v58, v58, v39
  v_and_b32 v187, s64, v33
  v_add_f32 v59, v187, v38
  v_mul_f32 v59, v59, v39
  s_waitcnt vmcnt(11)
  v_mfma_f32_32x32x16_bf16 v[192:207], a[0:3], v[112:115], 0
  v_lshlrev_b32 v188, 16, v34
  v_add_f32 v60, v188, v38
  v_mul_f32 v60, v60, v39
  v_and_b32 v189, s64, v34
  v_add_f32 v61, v189, v38
  v_mfma_f32_32x32x16_bf16 v[208:223], a[4:7], v[112:115], 0
  buffer_load_dwordx4 v[96:99], v2, s[48:51], s77 offen offset:0 sc1
  v_mul_f32 v61, v61, v39
  v_lshlrev_b32 v190, 16, v35
  v_add_f32 v62, v190, v38
  v_mul_f32 v62, v62, v39
  v_and_b32 v191, s64, v35
  s_waitcnt vmcnt(11)
  v_mfma_f32_32x32x16_bf16 v[192:207], a[8:11], v[116:119], v[192:207]
  ds_write_b128 v10, v[224:227] offset:1024
  v_add_f32 v63, v191, v38
  v_mfma_f32_32x32x16_bf16 v[208:223], a[12:15], v[116:119], v[208:223]
  buffer_load_dwordx4 v[100:103], v2, s[48:51], s77 offen offset:1024 sc1
  v_mul_f32 v63, v63, v39
  s_waitcnt vmcnt(11)
  v_mfma_f32_32x32x16_bf16 v[192:207], a[16:19], v[120:123], v[192:207]
  ds_write_b128 v11, v[228:231] offset:1024
  v_mfma_f32_32x32x16_bf16 v[208:223], a[20:23], v[120:123], v[208:223]
  buffer_load_dwordx4 v[104:107], v2, s[48:51], s77 offen offset:2048 sc1
  s_waitcnt vmcnt(11)
  v_mfma_f32_32x32x16_bf16 v[192:207], a[24:27], v[124:127], v[192:207]
  ds_write_b128 v12, v[232:235] offset:1024
  v_mfma_f32_32x32x16_bf16 v[208:223], a[28:31], v[124:127], v[208:223]
  buffer_load_dwordx4 v[108:111], v2, s[48:51], s77 offen offset:3072 sc1
  s_add_u32 s77, s77, 4096
  s_waitcnt vmcnt(11)
  v_mfma_f32_32x32x16_bf16 v[192:207], a[32:35], v[64:67], v[192:207]
  ds_write_b128 v13, v[236:239] offset:1024
  v_mfma_f32_32x32x16_bf16 v[208:223], a[36:39], v[64:67], v[208:223]
  buffer_load_dwordx4 v[112:115], v2, s[48:51], s77 offen offset:0 sc1
  s_waitcnt vmcnt(11)
  v_mfma_f32_32x32x16_bf16 v[192:207], a[40:43], v[68:71], v[192:207]
  ds_write_b128 v10, v[240:243] offset:1152
  v_mfma_f32_32x32x16_bf16 v[208:223], a[44:47], v[68:71], v[208:223]
  buffer_load_dwordx4 v[116:119], v2, s[48:51], s77 offen offset:1024 sc1
  s_waitcnt vmcnt(11)
  v_mfma_f32_32x32x16_bf16 v[192:207], a[48:51], v[72:75], v[192:207]
  ds_write_b128 v11, v[244:247] offset:1152
  v_mfma_f32_32x32x16_bf16 v[208:223], a[52:55], v[72:75], v[208:223]
  buffer_load_dwordx4 v[120:123], v2, s[48:51], s77 offen offset:2048 sc1
  s_waitcnt vmcnt(11)
  v_mfma_f32_32x32x16_bf16 v[192:207], a[56:59], v[76:79], v[192:207]
  ds_write_b128 v12, v[248:251] offset:1152
  v_mfma_f32_32x32x16_bf16 v[208:223], a[60:63], v[76:79], v[208:223]
  buffer_load_dwordx4 v[124:127], v2, s[48:51], s77 offen offset:3072 sc1
  s_add_u32 s77, s77, 4096
  s_waitcnt vmcnt(11)
  v_mfma_f32_32x32x16_bf16 v[192:207], a[64:67], v[80:83], v[192:207]
  ds_write_b128 v13, v[252:255] offset:1152
  v_mfma_f32_32x32x16_bf16 v[208:223], a[68:71], v[80:83], v[208:223]
  buffer_load_dwordx4 v[64:67], v2, s[48:51], s77 offen offset:0 sc1
  s_waitcnt vmcnt(11)
  v_mfma_f32_32x32x16_bf16 v[192:207], a[72:75], v[84:87], v[192:207]
  v_mfma_f32_32x32x16_bf16 v[208:223], a[76:79], v[84:87], v[208:223]
  buffer_load_dwordx4 v[68:71], v2, s[48:51], s77 offen offset:1024 sc1
  s_waitcnt lgkmcnt(0)
  s_barrier
  ds_read_b128 v[128:131], v8 offset:1024
  ds_read_b128 v[132:135], v9 offset:1024
  s_waitcnt vmcnt(11)
  v_mfma_f32_32x32x16_bf16 v[192:207], a[80:83], v[88:91], v[192:207]
  ds_read_b128 v[136:139], v8 offset:5120
  ds_read_b128 v[140:143], v9 offset:5120
  ds_read_b128 v[144:147], v8 offset:9216
  v_mfma_f32_32x32x16_bf16 v[208:223], a[84:87], v[88:91], v[208:223]
  buffer_load_dwordx4 v[72:75], v2, s[48:51], s77 offen offset:2048 sc1
  ds_read_b128 v[148:151], v9 offset:9216
  ds_read_b128 v[152:155], v8 offset:13312
  ds_read_b128 v[156:159], v9 offset:13312
  s_waitcnt vmcnt(11)
  v_mfma_f32_32x32x16_bf16 v[192:207], a[88:91], v[92:95], v[192:207]
  v_mfma_f32_32x32x16_bf16 v[208:223], a[92:95], v[92:95], v[208:223]
  buffer_load_dwordx4 v[76:79], v2, s[48:51], s77 offen offset:3072 sc1
  s_add_u32 s77, s77, 4096
  s_waitcnt vmcnt(11)
  v_mfma_f32_32x32x16_bf16 v[192:207], a[96:99], v[96:99], v[192:207]
  s_waitcnt lgkmcnt(0)
  v_add_f32 v128, v128, v136
  v_add_f32 v144, v144, v152
  v_add_f32 v129, v129, v137
  v_add_f32 v145, v145, v153
  v_mfma_f32_32x32x16_bf16 v[208:223], a[100:103], v[96:99], v[208:223]
  buffer_load_dwordx4 v[80:83], v2, s[48:51], s77 offen offset:0 sc1
  v_add_f32 v130, v130, v138
  v_add_f32 v146, v146, v154
  v_add_f32 v131, v131, v139
  v_add_f32 v147, v147, v155
  v_add_f32 v132, v132, v140
  s_waitcnt vmcnt(11)
  v_mfma_f32_32x32x16_bf16 v[192:207], a[104:107], v[100:103], v[192:207]
  v_add_f32 v148, v148, v156
  v_add_f32 v133, v133, v141
  v_add_f32 v149, v149, v157
  v_add_f32 v134, v134, v142
  v_add_f32 v150, v150, v158
  v_mfma_f32_32x32x16_bf16 v[208:223], a[108:111], v[100:103], v[208:223]
  buffer_load_dwordx4 v[84:87], v2, s[48:51], s77 offen offset:1024 sc1
  v_add_f32 v135, v135, v143
  v_add_f32 v151, v151, v159
  v_add_f32 v128, v128, v144
  v_add_f32 v129, v129, v145
  v_add_f32 v130, v130, v146
  s_waitcnt vmcnt(11)
  v_mfma_f32_32x32x16_bf16 v[192:207], a[112:115], v[104:107], v[192:207]
  v_add_f32 v131, v131, v147
  v_add_f32 v132, v132, v148
  v_add_f32 v133, v133, v149
  v_add_f32 v134, v134, v150
  v_add_f32 v135, v135, v151
  v_mfma_f32_32x32x16_bf16 v[208:223], a[116:119], v[104:107], v[208:223]
  buffer_load_dwordx4 v[88:91], v2, s[48:51], s77 offen offset:2048 sc1
  v_mul_f32 v136, s3, v128
  v_mul_f32 v137, s3, v129
  v_mul_f32 v138, s3, v130
  v_mul_f32 v139, s3, v131
  v_mul_f32 v140, s3, v132
  s_waitcnt vmcnt(11)
  v_mfma_f32_32x32x16_bf16 v[192:207], a[120:123], v[108:111], v[192:207]
  v_mul_f32 v141, s3, v133
  v_mul_f32 v142, s3, v134
  v_mul_f32 v143, s3, v135
  v_exp_f32 v136, v136
  v_mfma_f32_32x32x16_bf16 v[208:223], a[124:127], v[108:111], v[208:223]
  buffer_load_dwordx4 v[92:95], v2, s[48:51], s77 offen offset:3072 sc1
  s_add_u32 s77, s77, 90112
  v_mul_f32 v48, v128, v48
  v_exp_f32 v137, v137
  v_mul_f32 v49, v129, v49
  s_waitcnt vmcnt(11)
  v_mfma_f32_32x32x16_bf16 v[192:207], a[128:131], v[112:115], v[192:207]
  buffer_load_dword v0, off, s[48:51], s74 sc1
  v_exp_f32 v138, v138
  v_mul_f32 v50, v130, v50
  v_mfma_f32_32x32x16_bf16 v[208:223], a[132:135], v[112:115], v[208:223]
  v_exp_f32 v139, v139
  v_mul_f32 v51, v131, v51
  v_exp_f32 v140, v140
  v_mul_f32 v52, v132, v52
  s_waitcnt vmcnt(11)
  v_mfma_f32_32x32x16_bf16 v[192:207], a[136:139], v[116:119], v[192:207]
  v_exp_f32 v141, v141
  v_mul_f32 v53, v133, v53
  v_exp_f32 v142, v142
  v_mfma_f32_32x32x16_bf16 v[208:223], a[140:143], v[116:119], v[208:223]
  v_mul_f32 v54, v134, v54
  v_exp_f32 v143, v143
  v_mul_f32 v55, v135, v55
  v_add_f32 v136, 1.0, v136
  s_waitcnt vmcnt(10)
  v_mfma_f32_32x32x16_bf16 v[192:207], a[144:147], v[120:123], v[192:207]
  v_rcp_f32 v136, v136
  v_add_f32 v137, 1.0, v137
  v_rcp_f32 v137, v137
  v_mfma_f32_32x32x16_bf16 v[208:223], a[148:151], v[120:123], v[208:223]
  v_add_f32 v138, 1.0, v138
  v_mul_f32 v48, v48, v136
  v_rcp_f32 v138, v138
  v_add_f32 v139, 1.0, v139
  v_mul_f32 v49, v49, v137
  s_waitcnt vmcnt(9)
  v_mfma_f32_32x32x16_bf16 v[192:207], a[152:155], v[124:127], v[192:207]
  v_rcp_f32 v139, v139
  v_add_f32 v140, 1.0, v140
  v_mul_f32 v50, v50, v138
  v_mfma_f32_32x32x16_bf16 v[208:223], a[156:159], v[124:127], v[208:223]
  v_rcp_f32 v140, v140
  v_add_f32 v141, 1.0, v141
  v_mul_f32 v51, v51, v139
  v_rcp_f32 v141, v141
  s_waitcnt vmcnt(8)
  v_mfma_f32_32x32x16_bf16 v[192:207], a[160:163], v[64:67], v[192:207]
  v_add_f32 v142, 1.0, v142
  v_mul_f32 v52, v52, v140
  v_rcp_f32 v142, v142
  v_add_f32 v143, 1.0, v143
  v_mfma_f32_32x32x16_bf16 v[208:223], a[164:167], v[64:67], v[208:223]
  v_mul_f32 v53, v53, v141
  v_rcp_f32 v143, v143
  v_mul_f32 v54, v54, v142
  v_mul_f32 v55, v55, v143
  v_fmac_f32 v16, v48, v168
  s_waitcnt vmcnt(7)
  v_mfma_f32_32x32x16_bf16 v[192:207], a[168:171], v[68:71], v[192:207]
  v_fmac_f32 v17, v49, v169
  v_fmac_f32 v18, v50, v170
  v_fmac_f32 v19, v51, v171
  v_fmac_f32 v20, v52, v172
  v_fmac_f32 v21, v53, v173
  v_mfma_f32_32x32x16_bf16 v[208:223], a[172:175], v[68:71], v[208:223]
  v_fmac_f32 v22, v54, v174
  v_fmac_f32 v23, v55, v175
  s_waitcnt vmcnt(6)
  v_mfma_f32_32x32x16_bf16 v[192:207], a[176:179], v[72:75], v[192:207]
  s_waitcnt vmcnt(5)
  v_mfma_f32_32x32x16_bf16 v[192:207], a[184:187], v[76:79], v[192:207]
  s_waitcnt vmcnt(4)
  v_mfma_f32_32x32x16_bf16 v[192:207], a[192:195], v[80:83], v[192:207]
  s_waitcnt vmcnt(3)
  v_mfma_f32_32x32x16_bf16 v[192:207], a[200:203], v[84:87], v[192:207]
  s_waitcnt vmcnt(2)
  v_mfma_f32_32x32x16_bf16 v[192:207], a[208:211], v[88:91], v[192:207]
  s_waitcnt vmcnt(1)
  v_mfma_f32_32x32x16_bf16 v[192:207], a[216:219], v[92:95], v[192:207]
  v_mfma_f32_32x32x16_bf16 v[208:223], a[180:183], v[72:75], v[208:223]
  v_mfma_f32_32x32x16_bf16 v[208:223], a[188:191], v[76:79], v[208:223]
  v_mfma_f32_32x32x16_bf16 v[208:223], a[196:199], v[80:83], v[208:223]
  s_nop 8
  ds_write_b128 v10, v[192:195] offset:33792
  v_mfma_f32_32x32x16_bf16 v[208:223], a[204:207], v[84:87], v[208:223]
  ds_write_b128 v11, v[196:199] offset:33792
  v_mfma_f32_32x32x16_bf16 v[208:223], a[212:215], v[88:91], v[208:223]
  ds_write_b128 v12, v[200:203] offset:33792
  v_mfma_f32_32x32x16_bf16 v[208:223], a[220:223], v[92:95], v[208:223]
  ds_write_b128 v13, v[204:207] offset:33792
  s_waitcnt vmcnt(0)
  v_readfirstlane_b32 s57, v0
  s_nop 1
  s_cmp_ge_u32 s57, 32
  s_cbranch_scc1 Lok7
  s_mov_b32 s58, 100000
Lsp7:
  s_sleep 1
  buffer_load_dword v0, off, s[48:51], s74 sc1
  s_waitcnt vmcnt(0)
  v_readfirstlane_b32 s57, v0
  s_nop 1
  s_cmp_ge_u32 s57, 32
  s_cbranch_scc1 Lok7
  s_sub_u32 s58, s58, 1
  s_cmp_lg_u32 s58, 0
  s_cbranch_scc1 Lsp7
Lok7:
  s_add_u32 m0, s60, 132096
  s_nop 0
  buffer_load_dwordx4 v6, s[48:51], s78 offen sc1 lds
  s_add_u32 m0, s60, 132608
  s_nop 0
  buffer_load_dwordx4 v6, s[48:51], s78 offen offset:512 sc1 lds
  ds_write_b128 v10, v[208:211] offset:33920
  ds_write_b128 v11, v[212:215] offset:33920
  ds_write_b128 v12, v[216:219] offset:33920
  ds_write_b128 v13, v[220:223] offset:33920
  s_waitcnt lgkmcnt(0)
  s_barrier
  ds_read_b128 v[128:131], v8 offset:33792
  ds_read_b128 v[132:135], v9 offset:33792
  ds_read_b128 v[136:139], v8 offset:37888
  ds_read_b128 v[140:143], v9 offset:37888
  ds_read_b128 v[144:147], v8 offset:41984
  ds_read_b128 v[148:151], v9 offset:41984
  ds_read_b128 v[152:155], v8 offset:46080
  ds_read_b128 v[156:159], v9 offset:46080
  s_waitcnt lgkmcnt(0)
  v_pk_add_f32 v[128:129], v[128:129], v[136:137]
  v_pk_add_f32 v[144:145], v[144:145], v[152:153]
  v_pk_add_f32 v[130:131], v[130:131], v[138:139]
  v_pk_add_f32 v[146:147], v[146:147], v[154:155]
  v_pk_add_f32 v[132:133], v[132:133], v[140:141]
  v_pk_add_f32 v[148:149], v[148:149], v[156:157]
  v_pk_add_f32 v[134:135], v[134:135], v[142:143]
  v_pk_add_f32 v[150:151], v[150:151], v[158:159]
  v_pk_add_f32 v[128:129], v[128:129], v[144:145]
  v_pk_add_f32 v[130:131], v[130:131], v[146:147]
  v_pk_add_f32 v[132:133], v[132:133], v[148:149]
  v_pk_add_f32 v[134:135], v[134:135], v[150:151]
  v_mul_f32 v136, s3, v128
  v_mul_f32 v137, s3, v129
  v_mul_f32 v138, s3, v130
  v_mul_f32 v139, s3, v131
  v_mul_f32 v140, s3, v132
  v_mul_f32 v141, s3, v133
  v_mul_f32 v142, s3, v134
  v_mul_f32 v143, s3, v135
  v_exp_f32 v136, v136
  v_mul_f32 v56, v128, v56
  v_exp_f32 v137, v137
  v_mul_f32 v57, v129, v57
  v_exp_f32 v138, v138
  v_mul_f32 v58, v130, v58
  v_exp_f32 v139, v139
  v_mul_f32 v59, v131, v59
  v_exp_f32 v140, v140
  v_mul_f32 v60, v132, v60
  v_exp_f32 v141, v141
  v_mul_f32 v61, v133, v61
  v_exp_f32 v142, v142
  v_mul_f32 v62, v134, v62
  v_exp_f32 v143, v143
  v_mul_f32 v63, v135, v63
  v_add_f32 v136, 1.0, v136
  v_rcp_f32 v136, v136
  v_add_f32 v137, 1.0, v137
  v_rcp_f32 v137, v137
  v_add_f32 v138, 1.0, v138
  v_mul_f32 v56, v56, v136
  v_rcp_f32 v138, v138
  v_add_f32 v139, 1.0, v139
  v_mul_f32 v57, v57, v137
  v_rcp_f32 v139, v139
  v_add_f32 v140, 1.0, v140
  v_mul_f32 v58, v58, v138
  s_waitcnt vmcnt(0)
  ds_read2_b32 v[40:41], v7 offset0:0 offset1:8
  ds_read2_b32 v[42:43], v7 offset0:128 offset1:136
  ds_read2_b32 v[44:45], v5 offset0:0 offset1:8
  ds_read2_b32 v[46:47], v5 offset0:128 offset1:136
  v_rcp_f32 v140, v140
  v_add_f32 v141, 1.0, v141
  v_mul_f32 v59, v59, v139
  v_rcp_f32 v141, v141
  v_add_f32 v142, 1.0, v142
  v_mul_f32 v60, v60, v140
  v_rcp_f32 v142, v142
  v_add_f32 v143, 1.0, v143
  v_mul_f32 v61, v61, v141
  v_rcp_f32 v143, v143
  v_mul_f32 v62, v62, v142
  v_mul_f32 v63, v63, v143
  v_pk_fma_f32 v[184:185], v[56:57], v[176:177], v[184:185]
  v_pk_fma_f32 v[186:187], v[58:59], v[178:179], v[186:187]
  v_pk_fma_f32 v[188:189], v[60:61], v[180:181], v[188:189]
  v_pk_fma_f32 v[190:191], v[62:63], v[182:183], v[190:191]
  s_waitcnt lgkmcnt(0)
  v_lshlrev_b32 v136, 16, v40
  v_and_b32 v137, s64, v40
  v_lshlrev_b32 v138, 16, v42
  v_and_b32 v139, s64, v42
  v_lshlrev_b32 v140, 16, v44
  v_and_b32 v141, s64, v44
  v_lshlrev_b32 v142, 16, v46
  v_and_b32 v143, s64, v46
  v_pk_fma_f32 v[16:17], v[48:49], v[136:137], v[16:17]
  v_pk_fma_f32 v[18:19], v[50:51], v[138:139], v[18:19]
  v_pk_fma_f32 v[20:21], v[52:53], v[140:141], v[20:21]
  v_pk_fma_f32 v[22:23], v[54:55], v[142:143], v[22:23]
  v_cvt_pk_bf16_f32 v160, v16, v17
  v_cvt_pk_bf16_f32 v161, v18, v19
  v_cvt_pk_bf16_f32 v162, v20, v21
  v_cvt_pk_bf16_f32 v163, v22, v23
  buffer_store_dwordx4 v[160:163], v3, s[40:43], 0 offen
  v_lshlrev_b32 v136, 16, v41
  v_and_b32 v137, s64, v41
  v_lshlrev_b32 v138, 16, v43
  v_and_b32 v139, s64, v43
  v_lshlrev_b32 v140, 16, v45
  v_and_b32 v141, s64, v45
  v_lshlrev_b32 v142, 16, v47
  v_and_b32 v143, s64, v47
  v_pk_fma_f32 v[184:185], v[56:57], v[136:137], v[184:185]
  v_pk_fma_f32 v[186:187], v[58:59], v[138:139], v[186:187]
  v_pk_fma_f32 v[188:189], v[60:61], v[140:141], v[188:189]
  v_pk_fma_f32 v[190:191], v[62:63], v[142:143], v[190:191]
  v_cvt_pk_bf16_f32 v164, v184, v185
  v_cvt_pk_bf16_f32 v165, v186, v187
  v_cvt_pk_bf16_f32 v166, v188, v189
  v_cvt_pk_bf16_f32 v167, v190, v191
  buffer_store_dwordx4 v[164:167], v3, s[40:43], s1 offen
  s_endpgm
Lhelper:
  s_load_dwordx2 s[48:49], s[0:1], 96
  s_load_dwordx2 s[44:45], s[0:1], 88
  s_load_dwordx2 s[8:9], s[0:1], 8
  s_load_dwordx2 s[12:13], s[0:1], 16
  s_load_dwordx2 s[16:17], s[0:1], 24
  s_load_dwordx2 s[20:21], s[0:1], 32
  s_load_dwordx2 s[24:25], s[0:1], 40
  s_load_dwordx2 s[36:37], s[0:1], 72
  s_load_dwordx2 s[40:41], s[0:1], 80
  s_mov_b32 s10, 1835008
  s_mov_b32 s11, s7
  s_mov_b32 s14, 1835008
  s_mov_b32 s15, s7
  s_mov_b32 s22, 1835008
  s_mov_b32 s23, s7
  s_mov_b32 s38, 1605632
  s_mov_b32 s39, s7
  s_mov_b32 s46, 256
  s_mov_b32 s47, s7
  s_mov_b32 s50, 13631488
  s_mov_b32 s51, s7
  s_and_b32 s68, s57, 6
  s_lshl_b32 s68, s68, 1
  s_add_u32 s68, s68, s58
  s_lshl_b32 s68, s68, 1
  s_and_b32 s69, s57, 1
  s_add_u32 s68, s68, s69
  s_lshl_b32 s70, s68, 13
  s_mul_i32 s71, s58, 401408
  s_mul_i32 s68, s68, 57344
  s_lshr_b32 s59, s57, 1
  s_lshl_b32 s59, s59, 2
  s_add_u32 s59, s59, s58
  s_lshl_b32 s60, s57, 2
  s_add_u32 s55, s60, s58
  s_and_b32 s57, s57, 1
  s_mul_i32 s57, s57, 7
  s_cmp_ge_u32 s59, 7
  s_cselect_b32 s60, 7, 0
  s_cselect_b32 s61, 14336, 0
  s_sub_u32 s60, s59, s60
  s_add_u32 s54, s57, s60
  s_lshl_b32 s57, s55, 6
  s_lshl_b32 s58, s52, 4
  s_add_u32 s62, s57, s58
  v_lshrrev_b32 v14, 3, v1
  v_add_u32 v5, s62, v14
  v_and_b32 v4, 0x70, v2
  s_movk_i32 s57, 896
  v_mad_u32_u24 v4, v5, s57, v4
  s_lshl_b32 s57, s52, 2
  v_lshrrev_b32 v14, 4, v1
  v_add_u32 v14, s57, v14
  v_and_b32 v6, 0xf0, v2
  s_lshl_b32 s57, s54, 8
  v_add_u32 v6, s57, v6
  s_movk_i32 s57, 3584
  v_mad_u32_u24 v6, v14, s57, v6
  s_movk_i32 s67, 7168
  s_waitcnt lgkmcnt(0)
  s_cmp_ge_u32 s59, 7
  s_cselect_b32 s28, s32, s28
  s_cselect_b32 s29, s33, s29
  s_cmp_ge_u32 s59, 14
  s_cselect_b32 s30, 0, s30
  s_cmp_lg_u32 s2, 30
  s_cbranch_scc1 Lh1
  v_lshlrev_b32 v14, 7, v0
  v_mov_b32 v15, 0
  buffer_store_dword v15, v14, s[48:51], 0 offen sc1
  s_waitcnt vmcnt(0)
  s_barrier
  s_cmp_lg_u32 s52, 0
  s_cbranch_scc1 Lh1
  s_mov_b64 exec, 1
  v_mov_b32 v15, 1
  buffer_store_dword v15, off, s[44:47], 0 sc1
  s_mov_b64 exec, -1
Lh1:
  buffer_load_dwordx4 v[16:19], v4, s[4:7], 0 offen offset:128
  buffer_load_dwordx4 v[20:23], v4, s[4:7], s67 offen offset:128
  buffer_load_dwordx4 v[24:27], v4, s[4:7], 0 offen offset:256
  buffer_load_dwordx4 v[28:31], v4, s[4:7], s67 offen offset:256
  buffer_load_dwordx4 v[32:35], v4, s[4:7], 0 offen offset:384
  buffer_load_dwordx4 v[36:39], v4, s[4:7], s67 offen offset:384
  buffer_load_dwordx4 v[40:43], v4, s[4:7], 0 offen offset:512
  buffer_load_dwordx4 v[44:47], v4, s[4:7], s67 offen offset:512
  buffer_load_dwordx4 v[48:51], v4, s[4:7], 0 offen offset:640
  buffer_load_dwordx4 v[52:55], v4, s[4:7], s67 offen offset:640
  buffer_load_dwordx4 v[56:59], v4, s[4:7], 0 offen offset:768
  buffer_load_dwordx4 v[60:63], v4, s[4:7], s67 offen offset:768
  buffer_load_dwordx4 v[64:67], v4, s[4:7], 0 offen offset:0
  buffer_load_dwordx4 v[68:71], v4, s[4:7], s67 offen offset:0
  s_mov_b32 s63, 688128
  s_mov_b32 s64, 0x3f803f80
  s_movk_i32 s65, 0x3f80
  s_mov_b32 s66, 0x3f800000
  v_mov_b32 v8, 0
  v_mov_b32 v9, 0
  v_mov_b32 v10, 0
  v_mov_b32 v11, 0
  v_mov_b32 v72, 0
  v_mov_b32 v73, 0
  v_mov_b32 v74, 0
  v_mov_b32 v75, 0
  v_mov_b32 v76, 0
  v_mov_b32 v77, 0
  v_mov_b32 v78, 0
  v_mov_b32 v79, 0
  s_waitcnt vmcnt(13)
  buffer_load_dwordx4 v[80:83], v6, s[28:31], s63 offen
  s_mov_b32 s63, 745472
  v_dot2c_f32_bf16 v8, s64, v16
  v_dot2c_f32_bf16 v10, v16, v16
  v_dot2c_f32_bf16 v8, s64, v17
  v_dot2c_f32_bf16 v10, v17, v17
  v_dot2c_f32_bf16 v8, s64, v18
  v_dot2c_f32_bf16 v10, v18, v18
  v_dot2c_f32_bf16 v8, s64, v19
  v_dot2c_f32_bf16 v10, v19, v19
  s_waitcnt vmcnt(13)
  buffer_load_dwordx4 v[84:87], v6, s[28:31], s63 offen
  s_mov_b32 s63, 802816
  v_dot2c_f32_bf16 v9, s64, v20
  v_dot2c_f32_bf16 v11, v20, v20
  v_dot2c_f32_bf16 v9, s64, v21
  v_dot2c_f32_bf16 v11, v21, v21
  v_dot2c_f32_bf16 v9, s64, v22
  v_dot2c_f32_bf16 v11, v22, v22
  v_dot2c_f32_bf16 v9, s64, v23
  v_dot2c_f32_bf16 v11, v23, v23
  s_waitcnt vmcnt(13)
  buffer_load_dwordx4 v[88:91], v6, s[28:31], s63 offen
  s_mov_b32 s63, 860160
  v_dot2c_f32_bf16 v8, s64, v24
  v_dot2c_f32_bf16 v10, v24, v24
  v_dot2c_f32_bf16 v8, s64, v25
  v_dot2c_f32_bf16 v10, v25, v25
  v_dot2c_f32_bf16 v8, s64, v26
  v_dot2c_f32_bf16 v10, v26, v26
  v_dot2c_f32_bf16 v8, s64, v27
  v_dot2c_f32_bf16 v10, v27, v27
  s_waitcnt vmcnt(13)
  buffer_load_dwordx4 v[92:95], v6, s[28:31], s63 offen
  s_mov_b32 s63, 917504
  v_dot2c_f32_bf16 v9, s64, v28
  v_dot2c_f32_bf16 v11, v28, v28
  v_dot2c_f32_bf16 v9, s64, v29
  v_dot2c_f32_bf16 v11, v29, v29
  v_dot2c_f32_bf16 v9, s64, v30
  v_dot2c_f32_bf16 v11, v30, v30
  v_dot2c_f32_bf16 v9, s64, v31
  v_dot2c_f32_bf16 v11, v31, v31
  s_waitcnt vmcnt(13)
  buffer_load_dwordx4 v[96:99], v6, s[28:31], s63 offen
  s_mov_b32 s63, 974848
  v_dot2c_f32_bf16 v8, s64, v32
  v_dot2c_f32_bf16 v10, v32, v32
  v_dot2c_f32_bf16 v8, s64, v33
  v_dot2c_f32_bf16 v10, v33, v33
  v_dot2c_f32_bf16 v8, s64, v34
  v_dot2c_f32_bf16 v10, v34, v34
  v_dot2c_f32_bf16 v8, s64, v35
  v_dot2c_f32_bf16 v10, v35, v35
  s_waitcnt vmcnt(13)
  buffer_load_dwordx4 v[100:103], v6, s[28:31], s63 offen
  s_mov_b32 s63, 1032192
  v_dot2c_f32_bf16 v9, s64, v36
  v_dot2c_f32_bf16 v11, v36, v36
  v_dot2c_f32_bf16 v9, s64, v37
  v_dot2c_f32_bf16 v11, v37, v37
  v_dot2c_f32_bf16 v9, s64, v38
  v_dot2c_f32_bf16 v11, v38, v38
  v_dot2c_f32_bf16 v9, s64, v39
  v_dot2c_f32_bf16 v11, v39, v39
  s_waitcnt vmcnt(13)
  buffer_load_dwordx4 v[104:107], v6, s[28:31], s63 offen
  s_mov_b32 s63, 1089536
  v_dot2c_f32_bf16 v8, s64, v40
  v_dot2c_f32_bf16 v10, v40, v40
  v_dot2c_f32_bf16 v8, s64, v41
  v_dot2c_f32_bf16 v10, v41, v41
  v_dot2c_f32_bf16 v8, s64, v42
  v_dot2c_f32_bf16 v10, v42, v42
  v_dot2c_f32_bf16 v8, s64, v43
  v_dot2c_f32_bf16 v10, v43, v43
  s_waitcnt vmcnt(13)
  buffer_load_dwordx4 v[108:111], v6, s[28:31], s63 offen
  s_mov_b32 s63, 1146880
  v_dot2c_f32_bf16 v9, s64, v44
  v_dot2c_f32_bf16 v11, v44, v44
  v_dot2c_f32_bf16 v9, s64, v45
  v_dot2c_f32_bf16 v11, v45, v45
  v_dot2c_f32_bf16 v9, s64, v46
  v_dot2c_f32_bf16 v11, v46, v46
  v_dot2c_f32_bf16 v9, s64, v47
  v_dot2c_f32_bf16 v11, v47, v47
  s_waitcnt vmcnt(13)
  buffer_load_dwordx4 v[112:115], v6, s[28:31], s63 offen
  s_mov_b32 s63, 1204224
  v_dot2c_f32_bf16 v8, s64, v48
  v_dot2c_f32_bf16 v10, v48, v48
  v_dot2c_f32_bf16 v8, s64, v49
  v_dot2c_f32_bf16 v10, v49, v49
  v_dot2c_f32_bf16 v8, s64, v50
  v_dot2c_f32_bf16 v10, v50, v50
  v_dot2c_f32_bf16 v8, s64, v51
  v_dot2c_f32_bf16 v10, v51, v51
  s_waitcnt vmcnt(13)
  buffer_load_dwordx4 v[116:119], v6, s[28:31], s63 offen
  s_mov_b32 s63, 1261568
  v_dot2c_f32_bf16 v9, s64, v52
  v_dot2c_f32_bf16 v11, v52, v52
  v_dot2c_f32_bf16 v9, s64, v53
  v_dot2c_f32_bf16 v11, v53, v53
  v_dot2c_f32_bf16 v9, s64, v54
  v_dot2c_f32_bf16 v11, v54, v54
  v_dot2c_f32_bf16 v9, s64, v55
  v_dot2c_f32_bf16 v11, v55, v55
  s_waitcnt vmcnt(13)
  buffer_load_dwordx4 v[120:123], v6, s[28:31], s63 offen
  s_mov_b32 s63, 1318912
  v_dot2c_f32_bf16 v8, s64, v56
  v_dot2c_f32_bf16 v10, v56, v56
  v_dot2c_f32_bf16 v8, s64, v57
  v_dot2c_f32_bf16 v10, v57, v57
  v_dot2c_f32_bf16 v8, s64, v58
  v_dot2c_f32_bf16 v10, v58, v58
  v_dot2c_f32_bf16 v8, s64, v59
  v_dot2c_f32_bf16 v10, v59, v59
  s_waitcnt vmcnt(13)
  buffer_load_dwordx4 v[124:127], v6, s[28:31], s63 offen
  s_mov_b32 s63, 1376256
  v_dot2c_f32_bf16 v9, s64, v60
  v_dot2c_f32_bf16 v11, v60, v60
  v_dot2c_f32_bf16 v9, s64, v61
  v_dot2c_f32_bf16 v11, v61, v61
  v_dot2c_f32_bf16 v9, s64, v62
  v_dot2c_f32_bf16 v11, v62, v62
  v_dot2c_f32_bf16 v9, s64, v63
  v_dot2c_f32_bf16 v11, v63, v63
  s_waitcnt vmcnt(13)
  buffer_load_dwordx4 v[128:131], v6, s[28:31], s63 offen
  s_mov_b32 s63, 1433600
  v_dot2c_f32_bf16 v8, s64, v64
  v_dot2c_f32_bf16 v10, v64, v64
  v_dot2c_f32_bf16 v8, s64, v65
  v_dot2c_f32_bf16 v10, v65, v65
  v_dot2c_f32_bf16 v8, s64, v66
  v_dot2c_f32_bf16 v10, v66, v66
  v_dot2c_f32_bf16 v8, s64, v67
  v_dot2c_f32_bf16 v10, v67, v67
  s_waitcnt vmcnt(13)
  buffer_load_dwordx4 v[132:135], v6, s[28:31], s63 offen
  s_mov_b32 s63, 1490944
  v_dot2c_f32_bf16 v9, s64, v68
  v_dot2c_f32_bf16 v11, v68, v68
  v_dot2c_f32_bf16 v9, s64, v69
  v_dot2c_f32_bf16 v11, v69, v69
  v_dot2c_f32_bf16 v9, s64, v70
  v_dot2c_f32_bf16 v11, v70, v70
  v_dot2c_f32_bf16 v9, s64, v71
  v_dot2c_f32_bf16 v11, v71, v71
  s_nop 2
  v_add_f32_dpp v8, v8, v8 quad_perm:[1,0,3,2] row_mask:0xf bank_mask:0xf
  v_add_f32_dpp v9, v9, v9 quad_perm:[1,0,3,2] row_mask:0xf bank_mask:0xf
  v_add_f32_dpp v10, v10, v10 quad_perm:[1,0,3,2] row_mask:0xf bank_mask:0xf
  v_add_f32_dpp v11, v11, v11 quad_perm:[1,0,3,2] row_mask:0xf bank_mask:0xf
  v_add_f32_dpp v8, v8, v8 quad_perm:[2,3,0,1] row_mask:0xf bank_mask:0xf
  v_add_f32_dpp v9, v9, v9 quad_perm:[2,3,0,1] row_mask:0xf bank_mask:0xf
  v_add_f32_dpp v10, v10, v10 quad_perm:[2,3,0,1] row_mask:0xf bank_mask:0xf
  v_add_f32_dpp v11, v11, v11 quad_perm:[2,3,0,1] row_mask:0xf bank_mask:0xf
  v_add_f32_dpp v8, v8, v8 row_half_mirror row_mask:0xf bank_mask:0xf
  v_add_f32_dpp v9, v9, v9 row_half_mirror row_mask:0xf bank_mask:0xf
  v_add_f32_dpp v10, v10, v10 row_half_mirror row_mask:0xf bank_mask:0xf
  v_add_f32_dpp v11, v11, v11 row_half_mirror row_mask:0xf bank_mask:0xf
  v_and_b32 v14, 1, v1
  v_cmp_eq_u32 vcc, 0, v14
  v_lshl_add_u32 v5, v14, 3, v5
  s_nop 0
  v_cndmask_b32 v8, v9, v8, vcc
  v_cndmask_b32 v10, v11, v10, vcc
  v_mul_f32 v8, 0xbb124925, v8
  v_mul_f32 v10, 0x3b124925, v10
  v_fma_f32 v10, -v8, v8, v10
  v_max_f32 v10, 0, v10
  v_cvt_pk_bf16_f32 v8, v8, v8
  v_cvt_pk_bf16_f32 v10, v10, v10
  v_and_b32 v10, 0xffff0000, v10
  v_add_f32 v10, 0x3727c5ac, v10
  v_cvt_pk_bf16_f32 v10, v10, v10
  v_and_b32 v10, 0xffff0000, v10
  v_sqrt_f32 v10, v10
  v_lshlrev_b32 v5, 3, v5
  v_cvt_pk_bf16_f32 v10, v10, v10
  v_and_b32 v9, 0xffff0000, v10
  s_waitcnt vmcnt(13)
  buffer_load_dwordx4 v[136:139], v6, s[28:31], s63 offen
  s_mov_b32 s63, 1548288
  v_dot2c_f32_bf16 v72, s65, v80
  v_dot2c_f32_bf16 v73, s66, v80
  v_dot2c_f32_bf16 v74, s65, v81
  v_dot2c_f32_bf16 v75, s66, v81
  v_dot2c_f32_bf16 v76, s65, v82
  v_dot2c_f32_bf16 v77, s66, v82
  v_dot2c_f32_bf16 v78, s65, v83
  v_dot2c_f32_bf16 v79, s66, v83
  s_waitcnt vmcnt(13)
  buffer_load_dwordx4 v[140:143], v6, s[28:31], s63 offen
  s_mov_b32 s63, 0
  v_dot2c_f32_bf16 v72, s65, v84
  v_dot2c_f32_bf16 v73, s66, v84
  v_dot2c_f32_bf16 v74, s65, v85
  v_dot2c_f32_bf16 v75, s66, v85
  v_dot2c_f32_bf16 v76, s65, v86
  v_dot2c_f32_bf16 v77, s66, v86
  v_dot2c_f32_bf16 v78, s65, v87
  v_dot2c_f32_bf16 v79, s66, v87
  s_waitcnt vmcnt(13)
  buffer_load_dwordx4 v[144:147], v6, s[28:31], s63 offen
  s_mov_b32 s63, 57344
  v_dot2c_f32_bf16 v72, s65, v88
  v_dot2c_f32_bf16 v73, s66, v88
  v_dot2c_f32_bf16 v74, s65, v89
  v_dot2c_f32_bf16 v75, s66, v89
  v_dot2c_f32_bf16 v76, s65, v90
  v_dot2c_f32_bf16 v77, s66, v90
  v_dot2c_f32_bf16 v78, s65, v91
  v_dot2c_f32_bf16 v79, s66, v91
  s_waitcnt vmcnt(13)
  buffer_load_dwordx4 v[148:151], v6, s[28:31], s63 offen
  s_mov_b32 s63, 114688
  v_dot2c_f32_bf16 v72, s65, v92
  v_dot2c_f32_bf16 v73, s66, v92
  v_dot2c_f32_bf16 v74, s65, v93
  v_dot2c_f32_bf16 v75, s66, v93
  v_dot2c_f32_bf16 v76, s65, v94
  v_dot2c_f32_bf16 v77, s66, v94
  v_dot2c_f32_bf16 v78, s65, v95
  v_dot2c_f32_bf16 v79, s66, v95
  s_waitcnt vmcnt(13)
  buffer_load_dwordx4 v[152:155], v6, s[28:31], s63 offen
  s_mov_b32 s63, 172032
  v_dot2c_f32_bf16 v72, s65, v96
  v_dot2c_f32_bf16 v73, s66, v96
  v_dot2c_f32_bf16 v74, s65, v97
  v_dot2c_f32_bf16 v75, s66, v97
  v_dot2c_f32_bf16 v76, s65, v98
  v_dot2c_f32_bf16 v77, s66, v98
  v_dot2c_f32_bf16 v78, s65, v99
  v_dot2c_f32_bf16 v79, s66, v99
  s_waitcnt vmcnt(13)
  buffer_load_dwordx4 v[156:159], v6, s[28:31], s63 offen
  s_mov_b32 s63, 229376
  v_dot2c_f32_bf16 v72, s65, v100
  v_dot2c_f32_bf16 v73, s66, v100
  v_dot2c_f32_bf16 v74, s65, v101
  v_dot2c_f32_bf16 v75, s66, v101
  v_dot2c_f32_bf16 v76, s65, v102
  v_dot2c_f32_bf16 v77, s66, v102
  v_dot2c_f32_bf16 v78, s65, v103
  v_dot2c_f32_bf16 v79, s66, v103
  s_waitcnt vmcnt(13)
  buffer_load_dwordx4 v[160:163], v6, s[28:31], s63 offen
  s_mov_b32 s63, 286720
  v_dot2c_f32_bf16 v72, s65, v104
  v_dot2c_f32_bf16 v73, s66, v104
  v_dot2c_f32_bf16 v74, s65, v105
  v_dot2c_f32_bf16 v75, s66, v105
  v_dot2c_f32_bf16 v76, s65, v106
  v_dot2c_f32_bf16 v77, s66, v106
  v_dot2c_f32_bf16 v78, s65, v107
  v_dot2c_f32_bf16 v79, s66, v107
  s_waitcnt vmcnt(13)
  buffer_load_dwordx4 v[164:167], v6, s[28:31], s63 offen
  s_mov_b32 s63, 344064
  v_dot2c_f32_bf16 v72, s65, v108
  v_dot2c_f32_bf16 v73, s66, v108
  v_dot2c_f32_bf16 v74, s65, v109
  v_dot2c_f32_bf16 v75, s66, v109
  v_dot2c_f32_bf16 v76, s65, v110
  v_dot2c_f32_bf16 v77, s66, v110
  v_dot2c_f32_bf16 v78, s65, v111
  v_dot2c_f32_bf16 v79, s66, v111
  s_waitcnt vmcnt(13)
  buffer_load_dwordx4 v[168:171], v6, s[28:31], s63 offen
  s_mov_b32 s63, 401408
  v_dot2c_f32_bf16 v72, s65, v112
  v_dot2c_f32_bf16 v73, s66, v112
  v_dot2c_f32_bf16 v74, s65, v113
  v_dot2c_f32_bf16 v75, s66, v113
  v_dot2c_f32_bf16 v76, s65, v114
  v_dot2c_f32_bf16 v77, s66, v114
  v_dot2c_f32_bf16 v78, s65, v115
  v_dot2c_f32_bf16 v79, s66, v115
  s_waitcnt vmcnt(13)
  buffer_load_dwordx4 v[172:175], v6, s[28:31], s63 offen
  s_mov_b32 s63, 458752
  v_dot2c_f32_bf16 v72, s65, v116
  v_dot2c_f32_bf16 v73, s66, v116
  v_dot2c_f32_bf16 v74, s65, v117
  v_dot2c_f32_bf16 v75, s66, v117
  v_dot2c_f32_bf16 v76, s65, v118
  v_dot2c_f32_bf16 v77, s66, v118
  v_dot2c_f32_bf16 v78, s65, v119
  v_dot2c_f32_bf16 v79, s66, v119
  s_waitcnt vmcnt(13)
  buffer_load_dwordx4 v[176:179], v6, s[28:31], s63 offen
  s_mov_b32 s63, 516096
  v_dot2c_f32_bf16 v72, s65, v120
  v_dot2c_f32_bf16 v73, s66, v120
  v_dot2c_f32_bf16 v74, s65, v121
  v_dot2c_f32_bf16 v75, s66, v121
  v_dot2c_f32_bf16 v76, s65, v122
  v_dot2c_f32_bf16 v77, s66, v122
  v_dot2c_f32_bf16 v78, s65, v123
  v_dot2c_f32_bf16 v79, s66, v123
  s_waitcnt vmcnt(13)
  buffer_load_dwordx4 v[180:183], v6, s[28:31], s63 offen
  s_mov_b32 s63, 573440
  v_dot2c_f32_bf16 v72, s65, v124
  v_dot2c_f32_bf16 v73, s66, v124
  v_dot2c_f32_bf16 v74, s65, v125
  v_dot2c_f32_bf16 v75, s66, v125
  v_dot2c_f32_bf16 v76, s65, v126
  v_dot2c_f32_bf16 v77, s66, v126
  v_dot2c_f32_bf16 v78, s65, v127
  v_dot2c_f32_bf16 v79, s66, v127
  s_waitcnt vmcnt(13)
  buffer_load_dwordx4 v[184:187], v6, s[28:31], s63 offen
  s_mov_b32 s63, 630784
  v_dot2c_f32_bf16 v72, s65, v128
  v_dot2c_f32_bf16 v73, s66, v128
  v_dot2c_f32_bf16 v74, s65, v129
  v_dot2c_f32_bf16 v75, s66, v129
  v_dot2c_f32_bf16 v76, s65, v130
  v_dot2c_f32_bf16 v77, s66, v130
  v_dot2c_f32_bf16 v78, s65, v131
  v_dot2c_f32_bf16 v79, s66, v131
  s_waitcnt vmcnt(13)
  buffer_load_dwordx4 v[188:191], v6, s[28:31], s63 offen
  s_mov_b32 s63, 688128
  v_dot2c_f32_bf16 v72, s65, v132
  v_dot2c_f32_bf16 v73, s66, v132
  v_dot2c_f32_bf16 v74, s65, v133
  v_dot2c_f32_bf16 v75, s66, v133
  v_dot2c_f32_bf16 v76, s65, v134
  v_dot2c_f32_bf16 v77, s66, v134
  v_dot2c_f32_bf16 v78, s65, v135
  v_dot2c_f32_bf16 v79, s66, v135
  s_waitcnt vmcnt(13)
  v_dot2c_f32_bf16 v72, s65, v136
  v_dot2c_f32_bf16 v73, s66, v136
  v_dot2c_f32_bf16 v74, s65, v137
  v_dot2c_f32_bf16 v75, s66, v137
  v_dot2c_f32_bf16 v76, s65, v138
  v_dot2c_f32_bf16 v77, s66, v138
  v_dot2c_f32_bf16 v78, s65, v139
  v_dot2c_f32_bf16 v79, s66, v139
  s_waitcnt vmcnt(12)
  v_dot2c_f32_bf16 v72, s65, v140
  v_dot2c_f32_bf16 v73, s66, v140
  v_dot2c_f32_bf16 v74, s65, v141
  v_dot2c_f32_bf16 v75, s66, v141
  v_dot2c_f32_bf16 v76, s65, v142
  v_dot2c_f32_bf16 v77, s66, v142
  v_dot2c_f32_bf16 v78, s65, v143
  v_dot2c_f32_bf16 v79, s66, v143
  s_waitcnt vmcnt(11)
  v_dot2c_f32_bf16 v72, s65, v144
  v_dot2c_f32_bf16 v73, s66, v144
  v_dot2c_f32_bf16 v74, s65, v145
  v_dot2c_f32_bf16 v75, s66, v145
  v_dot2c_f32_bf16 v76, s65, v146
  v_dot2c_f32_bf16 v77, s66, v146
  v_dot2c_f32_bf16 v78, s65, v147
  v_dot2c_f32_bf16 v79, s66, v147
  s_mov_b32 exec_lo, 0x03030303
  s_mov_b32 exec_hi, 0x03030303
  s_mov_b32 s57, 32768
  buffer_store_dwordx2 v[8:9], v5, s[48:51], s57 offen sc1
  s_mov_b64 exec, -1
  s_waitcnt vmcnt(11)
  v_dot2c_f32_bf16 v72, s65, v148
  v_dot2c_f32_bf16 v73, s66, v148
  v_dot2c_f32_bf16 v74, s65, v149
  v_dot2c_f32_bf16 v75, s66, v149
  v_dot2c_f32_bf16 v76, s65, v150
  v_dot2c_f32_bf16 v77, s66, v150
  v_dot2c_f32_bf16 v78, s65, v151
  v_dot2c_f32_bf16 v79, s66, v151
  s_waitcnt vmcnt(10)
  v_dot2c_f32_bf16 v72, s65, v152
  v_dot2c_f32_bf16 v73, s66, v152
  v_dot2c_f32_bf16 v74, s65, v153
  v_dot2c_f32_bf16 v75, s66, v153
  v_dot2c_f32_bf16 v76, s65, v154
  v_dot2c_f32_bf16 v77, s66, v154
  v_dot2c_f32_bf16 v78, s65, v155
  v_dot2c_f32_bf16 v79, s66, v155
  s_waitcnt vmcnt(9)
  v_dot2c_f32_bf16 v72, s65, v156
  v_dot2c_f32_bf16 v73, s66, v156
  v_dot2c_f32_bf16 v74, s65, v157
  v_dot2c_f32_bf16 v75, s66, v157
  v_dot2c_f32_bf16 v76, s65, v158
  v_dot2c_f32_bf16 v77, s66, v158
  v_dot2c_f32_bf16 v78, s65, v159
  v_dot2c_f32_bf16 v79, s66, v159
  s_waitcnt vmcnt(8)
  v_dot2c_f32_bf16 v72, s65, v160
  v_dot2c_f32_bf16 v73, s66, v160
  v_dot2c_f32_bf16 v74, s65, v161
  v_dot2c_f32_bf16 v75, s66, v161
  v_dot2c_f32_bf16 v76, s65, v162
  v_dot2c_f32_bf16 v77, s66, v162
  v_dot2c_f32_bf16 v78, s65, v163
  v_dot2c_f32_bf16 v79, s66, v163
  s_waitcnt vmcnt(7)
  v_dot2c_f32_bf16 v72, s65, v164
  v_dot2c_f32_bf16 v73, s66, v164
  v_dot2c_f32_bf16 v74, s65, v165
  v_dot2c_f32_bf16 v75, s66, v165
  v_dot2c_f32_bf16 v76, s65, v166
  v_dot2c_f32_bf16 v77, s66, v166
  v_dot2c_f32_bf16 v78, s65, v167
  v_dot2c_f32_bf16 v79, s66, v167
  s_waitcnt vmcnt(6)
  v_dot2c_f32_bf16 v72, s65, v168
  v_dot2c_f32_bf16 v73, s66, v168
  v_dot2c_f32_bf16 v74, s65, v169
  v_dot2c_f32_bf16 v75, s66, v169
  v_dot2c_f32_bf16 v76, s65, v170
  v_dot2c_f32_bf16 v77, s66, v170
  v_dot2c_f32_bf16 v78, s65, v171
  v_dot2c_f32_bf16 v79, s66, v171
  s_waitcnt vmcnt(5)
  v_dot2c_f32_bf16 v72, s65, v172
  v_dot2c_f32_bf16 v73, s66, v172
  v_dot2c_f32_bf16 v74, s65, v173
  v_dot2c_f32_bf16 v75, s66, v173
  v_dot2c_f32_bf16 v76, s65, v174
  v_dot2c_f32_bf16 v77, s66, v174
  v_dot2c_f32_bf16 v78, s65, v175
  v_dot2c_f32_bf16 v79, s66, v175
  s_waitcnt vmcnt(4)
  v_dot2c_f32_bf16 v72, s65, v176
  v_dot2c_f32_bf16 v73, s66, v176
  v_dot2c_f32_bf16 v74, s65, v177
  v_dot2c_f32_bf16 v75, s66, v177
  v_dot2c_f32_bf16 v76, s65, v178
  v_dot2c_f32_bf16 v77, s66, v178
  v_dot2c_f32_bf16 v78, s65, v179
  v_dot2c_f32_bf16 v79, s66, v179
  s_waitcnt vmcnt(3)
  v_dot2c_f32_bf16 v72, s65, v180
  v_dot2c_f32_bf16 v73, s66, v180
  v_dot2c_f32_bf16 v74, s65, v181
  v_dot2c_f32_bf16 v75, s66, v181
  v_dot2c_f32_bf16 v76, s65, v182
  v_dot2c_f32_bf16 v77, s66, v182
  v_dot2c_f32_bf16 v78, s65, v183
  v_dot2c_f32_bf16 v79, s66, v183
  s_waitcnt vmcnt(2)
  v_dot2c_f32_bf16 v72, s65, v184
  v_dot2c_f32_bf16 v73, s66, v184
  v_dot2c_f32_bf16 v74, s65, v185
  v_dot2c_f32_bf16 v75, s66, v185
  v_dot2c_f32_bf16 v76, s65, v186
  v_dot2c_f32_bf16 v77, s66, v186
  v_dot2c_f32_bf16 v78, s65, v187
  v_dot2c_f32_bf16 v79, s66, v187
  s_waitcnt vmcnt(1)
  v_dot2c_f32_bf16 v72, s65, v188
  v_dot2c_f32_bf16 v73, s66, v188
  v_dot2c_f32_bf16 v74, s65, v189
  v_dot2c_f32_bf16 v75, s66, v189
  v_dot2c_f32_bf16 v76, s65, v190
  v_dot2c_f32_bf16 v77, s66, v190
  v_dot2c_f32_bf16 v78, s65, v191
  v_dot2c_f32_bf16 v79, s66, v191
  v_lshlrev_b32 v14, 5, v0
  s_nop 1
  ds_write_b128 v14, v[72:75]
  ds_write_b128 v14, v[76:79] offset:16
  v_and_b32 v14, 127, v0
  v_lshlrev_b32 v12, 2, v14
  s_waitcnt lgkmcnt(0)
  s_barrier
  ds_read_b32 v16, v12 offset:0
  ds_read_b32 v17, v12 offset:512
  ds_read_b32 v18, v12 offset:1024
  ds_read_b32 v19, v12 offset:1536
  ds_read_b32 v20, v12 offset:2048
  ds_read_b32 v21, v12 offset:2560
  ds_read_b32 v22, v12 offset:3072
  ds_read_b32 v23, v12 offset:3584
  ds_read_b32 v24, v12 offset:4096
  ds_read_b32 v25, v12 offset:4608
  ds_read_b32 v26, v12 offset:5120
  ds_read_b32 v27, v12 offset:5632
  ds_read_b32 v28, v12 offset:6144
  ds_read_b32 v29, v12 offset:6656
  ds_read_b32 v30, v12 offset:7168
  ds_read_b32 v31, v12 offset:7680
  s_lshl_b32 s57, s54, 7
  v_add_lshl_u32 v14, v14, s57, 3
  s_add_u32 s61, s61, 49152
  s_waitcnt lgkmcnt(0)
  v_add_f32 v16, v16, v24
  v_add_f32 v17, v17, v25
  v_add_f32 v18, v18, v26
  v_add_f32 v19, v19, v27
  v_add_f32 v20, v20, v28
  v_add_f32 v21, v21, v29
  v_add_f32 v22, v22, v30
  v_add_f32 v23, v23, v31
  v_add_f32 v16, v16, v20
  v_add_f32 v17, v17, v21
  v_add_f32 v18, v18, v22
  v_add_f32 v19, v19, v23
  v_add_f32 v16, v16, v18
  v_add_f32 v17, v17, v19
  v_add_f32 v16, v16, v17
  v_and_b32 v17, 0xffff0000, v16
  v_sub_f32 v16, v16, v17
  v_and_b32 v18, 0xffff0000, v16
  v_sub_f32 v16, v16, v18
  v_lshrrev_b32 v17, 16, v17
  v_or_b32 v18, v18, v17
  v_lshrrev_b32 v19, 16, v16
  s_cmp_ge_u32 s59, 14
  s_cbranch_scc1 Lh2
  s_cmp_ge_u32 s52, 2
  s_cbranch_scc1 Lh2
  buffer_store_dwordx2 v[18:19], v14, s[48:51], s61 offen sc1
Lh2:
  v_lshlrev_b32 v43, 7, v1
  v_mov_b32 v44, 1
  s_waitcnt vmcnt(0)
  s_barrier
  s_cmp_lg_u32 s52, 0
  s_cbranch_scc1 Lsg11
  s_movk_i32 s59, 128
  s_mov_b64 exec, 1
  buffer_atomic_add v44, v43, s[44:47], s59 offen sc1
  s_mov_b64 exec, -1
Lsg11:
  s_lshl_b32 s57, s52, 18
  s_add_u32 s57, s57, s70
  buffer_load_dword a7, v43, s[20:23], s57 offen nt
  s_add_u32 s57, s57, 1048576
  buffer_load_dword a8, v43, s[20:23], s57 offen nt
  s_mul_i32 s57, s2, 50176
  v_lshlrev_b32 v14, 7, v0
  v_add_u32 v15, 32768, v14
  buffer_load_dword a0, v14, s[36:39], s57 offen
  v_min_u32 v15, 50048, v15
  buffer_load_dword a1, v15, s[36:39], s57 offen
  v_lshlrev_b32 v14, 7, v0
  s_add_u32 s57, s71, 143360
  buffer_load_dword a9, v14, s[36:39], s57 offen
  s_add_u32 s57, s57, 32768
  buffer_load_dword a9, v14, s[36:39], s57 offen
  s_add_u32 s57, s57, 32768
  buffer_load_dword a9, v14, s[36:39], s57 offen
  s_add_u32 s57, s57, 32768
  buffer_load_dword a9, v14, s[36:39], s57 offen
  s_add_u32 s57, s57, 32768
  buffer_load_dword a9, v14, s[36:39], s57 offen
  s_add_u32 s57, s57, 32768
  buffer_load_dword a9, v14, s[36:39], s57 offen
  s_add_u32 s57, s57, 32768
  buffer_load_dword a9, v14, s[36:39], s57 offen
  s_add_u32 s57, s57, 32768
  s_add_u32 s57, s71, 368640
  buffer_load_dword a9, v14, s[36:39], s57 offen
  s_add_u32 s57, s57, 32768
Lend:
  s_endpgm
.section .rodata,"a"
.p2align 6
.amdhsa_kernel recurrent_scan__ssm_conv_h3__swiglu_ffn__prompt_kernel
  .amdhsa_next_free_vgpr 512
  .amdhsa_next_free_sgpr 102
  .amdhsa_accum_offset 256
  .amdhsa_group_segment_fixed_size 0
  .amdhsa_kernarg_size 104
  .amdhsa_user_sgpr_count 2
  .amdhsa_user_sgpr_kernarg_segment_ptr 1
  .amdhsa_system_sgpr_workgroup_id_x 1
  .amdhsa_float_denorm_mode_32 3
.end_amdhsa_kernel
```
